```python
import torch

def _softmax(x, axis=-1):
    return torch.softmax(x, dim=axis)
def _gelu(x):
    return torch.nn.functional.gelu(x, approximate="tanh")
def _silu(x):
    return torch.nn.functional.silu(x)
def _sigmoid(x):
    return torch.sigmoid(x)
def _layernorm(x, axis=-1, eps=1e-5):
    m = x.mean(dim=axis, keepdim=True)
    v = x.var(dim=axis, keepdim=True, unbiased=False)
    return (x - m) / torch.sqrt(v + eps)
def _scatter_add(tgt, idx, src, axis=0):
    return tgt.clone().index_add_(axis, idx, src)
def _segment_sum(src, seg, n):
    out = torch.zeros((n,) + src.shape[1:], dtype=src.dtype)
    return out.index_add_(0, seg, src)
def _pad(x, pw):
    flat = tuple(v for pair in reversed(pw) for v in pair)
    return torch.nn.functional.pad(x, flat)

kernel_name = 'concat_heads__ssm_conv_h3__grouped_kv_mqa__prompt'

def setup_inputs():

    _w = (lambda a: (lambda t: t.to(torch.bfloat16) if t.is_floating_point() else t)(torch.as_tensor(a)))
    def _A_setup():
        B, S, D = 1, 2048, 640
        ks = 4
        return {
            "q": _w((lambda *s: torch.randn(*s, dtype=torch.bfloat16) * 0.05)(B, S, D)),
            "k": _w((lambda *s: torch.randn(*s, dtype=torch.bfloat16) * 0.4)(B, S, D)),
            "v": _w((lambda *s: torch.randn(*s, dtype=torch.bfloat16) * 0.2)(B, S, D)),
            "shift_k": _w((lambda *s: torch.randn(*s, dtype=torch.bfloat16) * 0.4)(D, ks) * 0.5),
            "ssm_k": _w((lambda *s: torch.randn(*s, dtype=torch.bfloat16) * 0.4)(D, S) * (1.0 / S ** 0.5)),
            "ssm_D": _w((lambda *s: torch.randn(*s, dtype=torch.bfloat16) * 0.2)(D)),
        }
    _A_in = _A_setup()

    def _B_setup():
        B, S, D, H = 1, 2048, 640, 32
        Dh = D // H
        return {
            "x": _w((lambda *s: torch.randn(*s, dtype=torch.bfloat16) * 0.05)(B, S, D)),
            "wq": _w((lambda *s: torch.randn(*s, dtype=torch.bfloat16) * 0.8)(D, H * Dh)),
            "wk": _w((lambda *s: torch.randn(*s, dtype=torch.bfloat16) * 0.8)(D, Dh)),
            "wv": _w((lambda *s: torch.randn(*s, dtype=torch.bfloat16) * 0.05)(D, Dh)),
            "wo": _w((lambda *s: torch.randn(*s, dtype=torch.bfloat16) * 0.05)(H * Dh, D)),
        }
    _B_in = _B_setup()

    return {
        "A_q": _A_in["q"],
        "A_k": _A_in["k"],
        "A_v": _A_in["v"],
        "A_shift_k": _A_in["shift_k"],
        "A_ssm_k": _A_in["ssm_k"],
        "A_ssm_D": _A_in["ssm_D"],
        "B_x": _B_in["x"],
        "B_wq": _B_in["wq"],
        "B_wk": _B_in["wk"],
        "B_wv": _B_in["wv"],
        "B_wo": _B_in["wo"],
    }

def reference(A_q, A_k, A_v, A_shift_k, A_ssm_k, A_ssm_D, B_x, B_wq, B_wk, B_wv, B_wo):
    def _A_ref(q, k, v, shift_k, ssm_k, ssm_D):
        B, S, D = q.shape
        ks = shift_k.shape[-1]
        k_pad = _pad(k, ((0, 0), (ks - 1, 0), (0, 0)))
        k_shift = torch.zeros_like(k)
        for t in range(ks):
            k_shift = k_shift + k_pad[:, t:t + S, :] * shift_k[:, ks - 1 - t][None, None, :]
        kv = k_shift * v
        L = 2 * S
        kv_pad = _pad(kv, ((0, 0), (0, S), (0, 0)))
        kf_pad = _pad(ssm_k, ((0, 0), (0, S)))
        kv_f = (lambda x, axes=(-2,-1): torch.fft.rfft2(x.float(), dim=axes))(kv_pad[:, None, :, :], axes=(1, 2))
        kf_f = (lambda x, axes=(-2,-1): torch.fft.rfft2(x.float(), dim=axes))(kf_pad[:, None, :], axes=(1, 2))
        kf_f = (lambda x, *d: x.permute(*d))(kf_f, 1, 2, 0)
        y_f = kv_f * kf_f[None, :, :, :]
        y = (lambda x, s, axes=(-2,-1): torch.fft.irfft2(x, s=s, dim=axes).to(torch.bfloat16))(y_f, (1, L), axes=(1, 2))[:, 0, :S, :]
        y = y + kv * ssm_D[None, None, :]
        return q * y

    def _B_ref(x, wq, wk, wv, wo):
        B, S, D = x.shape
        H = 32
        Dh = D // H
        q = (lambda x, *d: x.permute(*d))((x @ wq).reshape(B, S, H, Dh), 0, 2, 1, 3)
        k = x @ wk
        v = x @ wv
        scores = torch.einsum("bhqd,bkd->bhqk", q, k) * (Dh ** -0.5)
        p = _softmax(scores, axis=-1)
        o = torch.einsum("bhqk,bkd->bhqd", p, v)
        return (lambda x, *d: x.permute(*d))(o, 0, 2, 1, 3).reshape(B, S, H * Dh) @ wo

    a = _A_ref(A_q, A_k, A_v, A_shift_k, A_ssm_k, A_ssm_D)
    b = _B_ref(B_x, B_wq, B_wk, B_wv, B_wo)
    return torch.concatenate([a, b], axis=-1)
```

```asm
; @launch kernel=main_kernel grid=(256,1,1) block=(768,1,1) lds=163840
.amdgcn_target "amdgcn-amd-amdhsa--gfx950"
.text
.globl main_kernel
.p2align 8
.type main_kernel,@function
main_kernel:
    s_cmp_ge_u32 s2, 256
    s_cbranch_scc1 KM_END
    s_load_dwordx16 s[16:31], s[0:1], 0
    s_load_dwordx8 s[32:39], s[0:1], 64
    s_load_dwordx4 s[40:43], s[0:1], 96
    v_lshrrev_b32 v1, 6, v0
    v_and_b32 v2, 63, v0
    s_and_b32 s4, s2, 7
    s_lshr_b32 s5, s2, 3
    v_readfirstlane_b32 s3, v1
    s_lshr_b32 s6, s5, 3
    s_lshl_b32 s4, s4, 2
    s_add_u32 s4, s4, s6
    s_and_b32 s5, s5, 7
    s_xor_b32 s7, s4, s5
    s_and_b32 s7, s7, 1
    s_mul_i32 s8, s5, 160
    s_mul_i32 s59, s4, 81920
    s_mul_i32 s58, s5, 1280
    s_add_u32 s59, s59, s58
    v_and_b32 v0, 63, v0
    s_cmp_lt_u32 s3, 4
    s_cbranch_scc1 KM_CONS
    s_cmp_lt_u32 s3, 6
    s_cbranch_scc1 KM_LOADER
    s_cmp_lt_u32 s3, 8
    s_cbranch_scc1 KM_IDLE
    s_cmp_eq_u32 s3, 8
    s_cbranch_scc1 KM_KV
    s_lshl_b32 s14, s2, 4
    s_add_u32 s14, s14, s3
    s_cmp_eq_u32 s14, 9
    s_cbranch_scc0 KM_H2
    s_waitcnt lgkmcnt(0)
    s_mov_b64 s[62:63], s[40:41]
    s_mov_b64 s[40:41], s[42:43]
    s_mov_b64 s[42:43], s[62:63]
    s_setprio 3
    v_mov_b32 v4, 0
    v_lshlrev_b32 v7, 7, v2
    v_add_u32 v5, 11468800, v7
    v_add_u32 v9, 12288, v5
    global_store_dword v5, v4, s[40:41] sc1
    global_store_dword v9, v4, s[40:41] sc1
    v_add_u32 v9, 8192, v5
    global_store_dword v9, v4, s[40:41] sc1
    v_add_u32 v5, 11489280, v7
    v_add_u32 v9, 8192, v5
    v_add_u32 v10, 16384, v5
    global_store_dword v5, v4, s[40:41] sc1
    global_store_dword v9, v4, s[40:41] sc1
    global_store_dword v10, v4, s[40:41] sc1
    v_mov_b32 v6, 1
    s_barrier
    s_waitcnt vmcnt(0)
    s_mov_b64 exec, 3
    global_store_dword v7, v6, s[42:43] sc1
    s_mov_b64 exec, -1
    s_barrier
    s_branch KM_H3
KM_H2:
    s_sub_u32 s14, s3, 9
    s_getpc_b64 s[60:61]
CT1:
    s_and_b32 s62, s14, 3
    s_mul_i32 s62, s62, 960
    s_add_i32 s62, s62, KM_KVC-CT1
    s_max_i32 s62, s62, 0
    s_add_u32 s60, s60, s62
    s_addc_u32 s61, s61, 0
    s_load_dword s63, s[60:61], 0
    s_load_dword s63, s[60:61], 64
    s_load_dword s63, s[60:61], 128
    s_load_dword s63, s[60:61], 192
    s_load_dword s63, s[60:61], 256
    s_load_dword s63, s[60:61], 320
    s_load_dword s63, s[60:61], 384
    s_load_dword s63, s[60:61], 448
    s_load_dword s63, s[60:61], 512
    s_load_dword s63, s[60:61], 576
    s_load_dword s63, s[60:61], 640
    s_load_dword s63, s[60:61], 704
    s_load_dword s63, s[60:61], 768
    s_load_dword s63, s[60:61], 832
    s_load_dword s63, s[60:61], 896
    s_barrier
    s_barrier
    s_waitcnt lgkmcnt(0)
    s_mov_b64 s[62:63], s[40:41]
    s_mov_b64 s[40:41], s[42:43]
    s_mov_b64 s[42:43], s[62:63]
KM_H3:
    s_mov_b32 s44, s40
    s_and_b32 s45, s41, 0xffff
    s_mov_b32 s46, 11513856
    s_mov_b32 s47, 0x20000
    s_branch K2_HELPER
KM_KV:
    s_setprio 3
    s_lshr_b32 s6, s5, 1
    s_lshl_b32 s6, s6, 4
    s_lshl_b32 s10, s4, 6
    s_add_u32 s6, s6, s10
    s_mul_i32 s10, s6, 1280
    v_lshlrev_b32 v7, 4, v2
    v_add_u32 v13, 0, v2
    v_mul_u32_u24 v14, 3277, v13
    v_lshrrev_b32 v14, 16, v14
    v_mul_u32_u24 v14, 960, v14
    v_lshl_add_u32 v8, v13, 4, v14
    v_add_u32 v13, 64, v2
    v_mul_u32_u24 v14, 3277, v13
    v_lshrrev_b32 v14, 16, v14
    v_mul_u32_u24 v14, 960, v14
    v_lshl_add_u32 v9, v13, 4, v14
    v_add_u32 v13, 128, v2
    v_mul_u32_u24 v14, 3277, v13
    v_lshrrev_b32 v14, 16, v14
    v_mul_u32_u24 v14, 960, v14
    v_lshl_add_u32 v10, v13, 4, v14
    v_add_u32 v13, 192, v2
    v_mul_u32_u24 v14, 3277, v13
    v_lshrrev_b32 v14, 16, v14
    v_mul_u32_u24 v14, 960, v14
    v_lshl_add_u32 v11, v13, 4, v14
    v_add_u32 v13, 256, v2
    v_mul_u32_u24 v14, 3277, v13
    v_lshrrev_b32 v14, 16, v14
    v_mul_u32_u24 v14, 960, v14
    v_lshl_add_u32 v12, v13, 4, v14
    s_waitcnt lgkmcnt(0)
    s_mov_b64 s[62:63], s[40:41]
    s_mov_b64 s[40:41], s[42:43]
    s_mov_b64 s[42:43], s[62:63]
    s_mov_b32 s44, s28
    s_and_b32 s45, s29, 0xffff
    s_mov_b32 s46, 2621440
    s_mov_b32 s47, 0x20000
    s_bitcmp1_b32 s5, 0
    s_cselect_b32 s52, s34, s32
    s_cselect_b32 s53, s35, s33
    s_and_b32 s53, s53, 0xffff
    s_mov_b32 s54, 25600
    s_mov_b32 s55, 0x20000
    s_add_u32 s11, s10, 0
    s_mov_b32 m0, 102400
    s_nop 0
    buffer_load_dwordx4 v8, s[44:47], s11 offen lds
    s_mov_b32 m0, 103424
    s_nop 0
    buffer_load_dwordx4 v9, s[44:47], s11 offen lds
    s_mov_b32 m0, 104448
    s_nop 0
    buffer_load_dwordx4 v10, s[44:47], s11 offen lds
    s_mov_b32 m0, 105472
    s_nop 0
    buffer_load_dwordx4 v11, s[44:47], s11 offen lds
    s_mov_b32 m0, 106496
    s_nop 0
    buffer_load_dwordx4 v12, s[44:47], s11 offen lds
    s_mov_b32 m0, 71680
    s_mov_b32 s14, 0
    buffer_load_dwordx4 v7, s[52:55], s14 offen lds
    s_mov_b32 m0, 72704
    s_mov_b32 s14, 1024
    buffer_load_dwordx4 v7, s[52:55], s14 offen lds
    s_mov_b32 m0, 73728
    s_mov_b32 s14, 2048
    buffer_load_dwordx4 v7, s[52:55], s14 offen lds
    s_mov_b32 m0, 74752
    s_mov_b32 s14, 3072
    buffer_load_dwordx4 v7, s[52:55], s14 offen lds
    s_mov_b32 m0, 75776
    s_mov_b32 s14, 4096
    buffer_load_dwordx4 v7, s[52:55], s14 offen lds
    s_mov_b32 m0, 76800
    s_mov_b32 s14, 5120
    buffer_load_dwordx4 v7, s[52:55], s14 offen lds
    s_mov_b32 m0, 77824
    s_mov_b32 s14, 6144
    buffer_load_dwordx4 v7, s[52:55], s14 offen lds
    s_add_u32 s11, s10, 320
    s_mov_b32 m0, 107520
    s_nop 0
    buffer_load_dwordx4 v8, s[44:47], s11 offen lds
    s_mov_b32 m0, 108544
    s_nop 0
    buffer_load_dwordx4 v9, s[44:47], s11 offen lds
    s_mov_b32 m0, 109568
    s_nop 0
    buffer_load_dwordx4 v10, s[44:47], s11 offen lds
    s_mov_b32 m0, 110592
    s_nop 0
    buffer_load_dwordx4 v11, s[44:47], s11 offen lds
    s_mov_b32 m0, 111616
    s_nop 0
    buffer_load_dwordx4 v12, s[44:47], s11 offen lds
    s_mov_b32 m0, 78848
    s_mov_b32 s14, 7168
    buffer_load_dwordx4 v7, s[52:55], s14 offen lds
    s_mov_b32 m0, 79872
    s_mov_b32 s14, 8192
    buffer_load_dwordx4 v7, s[52:55], s14 offen lds
    s_mov_b32 m0, 80896
    s_mov_b32 s14, 9216
    buffer_load_dwordx4 v7, s[52:55], s14 offen lds
    s_mov_b32 m0, 81920
    s_mov_b32 s14, 10240
    buffer_load_dwordx4 v7, s[52:55], s14 offen lds
    s_mov_b32 m0, 82944
    s_mov_b32 s14, 11264
    buffer_load_dwordx4 v7, s[52:55], s14 offen lds
    s_mov_b32 m0, 83968
    s_mov_b32 s14, 12288
    buffer_load_dwordx4 v7, s[52:55], s14 offen lds
    s_add_u32 s11, s10, 640
    s_mov_b32 m0, 112640
    s_nop 0
    buffer_load_dwordx4 v8, s[44:47], s11 offen lds
    s_mov_b32 m0, 113664
    s_nop 0
    buffer_load_dwordx4 v9, s[44:47], s11 offen lds
    s_mov_b32 m0, 114688
    s_nop 0
    buffer_load_dwordx4 v10, s[44:47], s11 offen lds
    s_mov_b32 m0, 115712
    s_nop 0
    buffer_load_dwordx4 v11, s[44:47], s11 offen lds
    s_mov_b32 m0, 116736
    s_nop 0
    buffer_load_dwordx4 v12, s[44:47], s11 offen lds
    s_mov_b32 m0, 84992
    s_mov_b32 s14, 13312
    buffer_load_dwordx4 v7, s[52:55], s14 offen lds
    s_mov_b32 m0, 86016
    s_mov_b32 s14, 14336
    buffer_load_dwordx4 v7, s[52:55], s14 offen lds
    s_mov_b32 m0, 87040
    s_mov_b32 s14, 15360
    buffer_load_dwordx4 v7, s[52:55], s14 offen lds
    s_mov_b32 m0, 88064
    s_mov_b32 s14, 16384
    buffer_load_dwordx4 v7, s[52:55], s14 offen lds
    s_mov_b32 m0, 89088
    s_mov_b32 s14, 17408
    buffer_load_dwordx4 v7, s[52:55], s14 offen lds
    s_mov_b32 m0, 90112
    s_mov_b32 s14, 18432
    buffer_load_dwordx4 v7, s[52:55], s14 offen lds
    s_add_u32 s11, s10, 960
    s_mov_b32 m0, 117760
    s_nop 0
    buffer_load_dwordx4 v8, s[44:47], s11 offen lds
    s_mov_b32 m0, 118784
    s_nop 0
    buffer_load_dwordx4 v9, s[44:47], s11 offen lds
    s_mov_b32 m0, 119808
    s_nop 0
    buffer_load_dwordx4 v10, s[44:47], s11 offen lds
    s_mov_b32 m0, 120832
    s_nop 0
    buffer_load_dwordx4 v11, s[44:47], s11 offen lds
    s_mov_b32 m0, 121856
    s_nop 0
    buffer_load_dwordx4 v12, s[44:47], s11 offen lds
    s_mov_b32 m0, 91136
    s_mov_b32 s14, 19456
    buffer_load_dwordx4 v7, s[52:55], s14 offen lds
    s_mov_b32 m0, 92160
    s_mov_b32 s14, 20480
    buffer_load_dwordx4 v7, s[52:55], s14 offen lds
    s_mov_b32 m0, 93184
    s_mov_b32 s14, 21504
    buffer_load_dwordx4 v7, s[52:55], s14 offen lds
    s_mov_b32 m0, 94208
    s_mov_b32 s14, 22528
    buffer_load_dwordx4 v7, s[52:55], s14 offen lds
    s_mov_b32 m0, 95232
    s_mov_b32 s14, 23552
    buffer_load_dwordx4 v7, s[52:55], s14 offen lds
    s_mov_b32 m0, 96256
    s_mov_b32 s14, 24576
    buffer_load_dwordx4 v7, s[52:55], s14 offen lds
    s_barrier
    s_barrier
    s_mov_b32 s44, s40
    s_and_b32 s45, s41, 0xffff
    s_mov_b32 s46, 11513856
    s_mov_b32 s47, 0x20000
    v_and_b32 v3, 15, v2
    v_lshrrev_b32 v4, 4, v2
    v_add_u32 v5, s6, v3
    v_mul_u32_u24 v13, 320, v3
    v_lshl_add_u32 v13, v4, 4, v13
    v_add_u32 v13, 102400, v13
    v_bfe_u32 v14, v2, 2, 2
    v_lshl_add_u32 v14, v4, 3, v14
    v_mul_u32_u24 v14, 40, v14
    v_and_b32 v15, 3, v2
    v_lshl_add_u32 v14, v15, 3, v14
    v_add_u32 v14, 71680, v14
    v_mov_b32 v17, 0
    v_mov_b64 v[140:141], 0
    v_mov_b64 v[142:143], 0
    v_mov_b64 v[144:145], 0
    v_mov_b64 v[146:147], 0
    s_bitcmp1_b32 s5, 0
KM_KVC:
    s_waitcnt vmcnt(33)
    ds_read_b128 v[20:23], v13 offset:0
    ds_read_b64_tr_b16 v[40:41], v14 offset:0
    ds_read_b64_tr_b16 v[42:43], v14 offset:160
    ds_read_b64_tr_b16 v[44:45], v14 offset:32
    ds_read_b64_tr_b16 v[46:47], v14 offset:192
    ds_read_b128 v[24:27], v13 offset:64
    ds_read_b64_tr_b16 v[48:49], v14 offset:1280
    ds_read_b64_tr_b16 v[50:51], v14 offset:1440
    ds_read_b64_tr_b16 v[52:53], v14 offset:1312
    ds_read_b64_tr_b16 v[54:55], v14 offset:1472
    ds_read_b128 v[28:31], v13 offset:128
    ds_read_b64_tr_b16 v[56:57], v14 offset:2560
    ds_read_b64_tr_b16 v[58:59], v14 offset:2720
    ds_read_b64_tr_b16 v[60:61], v14 offset:2592
    ds_read_b64_tr_b16 v[62:63], v14 offset:2752
    ds_read_b128 v[32:35], v13 offset:192
    ds_read_b64_tr_b16 v[64:65], v14 offset:3840
    ds_read_b64_tr_b16 v[66:67], v14 offset:4000
    ds_read_b64_tr_b16 v[68:69], v14 offset:3872
    ds_read_b64_tr_b16 v[70:71], v14 offset:4032
    ds_read_b128 v[36:39], v13 offset:256
    ds_read_b64_tr_b16 v[72:73], v14 offset:5120
    ds_read_b64_tr_b16 v[74:75], v14 offset:5280
    ds_read_b64_tr_b16 v[76:77], v14 offset:5152
    ds_read_b64_tr_b16 v[78:79], v14 offset:5312
    s_cbranch_scc1 KM_KVV0
    s_waitcnt lgkmcnt(15)
    v_mfma_f32_16x16x32_bf16 v[140:143], v[40:43], v[20:23], v[140:143]
    v_mfma_f32_16x16x32_bf16 v[144:147], v[44:47], v[20:23], v[144:147]
    s_waitcnt lgkmcnt(15)
    v_mfma_f32_16x16x32_bf16 v[140:143], v[48:51], v[24:27], v[140:143]
    v_mfma_f32_16x16x32_bf16 v[144:147], v[52:55], v[24:27], v[144:147]
    s_waitcnt lgkmcnt(10)
    v_mfma_f32_16x16x32_bf16 v[140:143], v[56:59], v[28:31], v[140:143]
    v_mfma_f32_16x16x32_bf16 v[144:147], v[60:63], v[28:31], v[144:147]
    s_waitcnt lgkmcnt(5)
    v_mfma_f32_16x16x32_bf16 v[140:143], v[64:67], v[32:35], v[140:143]
    v_mfma_f32_16x16x32_bf16 v[144:147], v[68:71], v[32:35], v[144:147]
    s_waitcnt lgkmcnt(0)
    v_mfma_f32_16x16x32_bf16 v[140:143], v[72:75], v[36:39], v[140:143]
    v_mfma_f32_16x16x32_bf16 v[144:147], v[76:79], v[36:39], v[144:147]
    s_branch KM_KVX0
KM_KVV0:
    s_waitcnt lgkmcnt(15)
    v_mfma_f32_16x16x32_bf16 v[140:143], v[20:23], v[40:43], v[140:143]
    v_mfma_f32_16x16x32_bf16 v[144:147], v[20:23], v[44:47], v[144:147]
    s_waitcnt lgkmcnt(15)
    v_mfma_f32_16x16x32_bf16 v[140:143], v[24:27], v[48:51], v[140:143]
    v_mfma_f32_16x16x32_bf16 v[144:147], v[24:27], v[52:55], v[144:147]
    s_waitcnt lgkmcnt(10)
    v_mfma_f32_16x16x32_bf16 v[140:143], v[28:31], v[56:59], v[140:143]
    v_mfma_f32_16x16x32_bf16 v[144:147], v[28:31], v[60:63], v[144:147]
    s_waitcnt lgkmcnt(5)
    v_mfma_f32_16x16x32_bf16 v[140:143], v[32:35], v[64:67], v[140:143]
    v_mfma_f32_16x16x32_bf16 v[144:147], v[32:35], v[68:71], v[144:147]
    s_waitcnt lgkmcnt(0)
    v_mfma_f32_16x16x32_bf16 v[140:143], v[36:39], v[72:75], v[140:143]
    v_mfma_f32_16x16x32_bf16 v[144:147], v[36:39], v[76:79], v[144:147]
KM_KVX0:
    s_waitcnt vmcnt(22)
    ds_read_b128 v[80:83], v13 offset:5120
    ds_read_b64_tr_b16 v[100:101], v14 offset:6400
    ds_read_b64_tr_b16 v[102:103], v14 offset:6560
    ds_read_b64_tr_b16 v[104:105], v14 offset:6432
    ds_read_b64_tr_b16 v[106:107], v14 offset:6592
    ds_read_b128 v[84:87], v13 offset:5184
    ds_read_b64_tr_b16 v[108:109], v14 offset:7680
    ds_read_b64_tr_b16 v[110:111], v14 offset:7840
    ds_read_b64_tr_b16 v[112:113], v14 offset:7712
    ds_read_b64_tr_b16 v[114:115], v14 offset:7872
    ds_read_b128 v[88:91], v13 offset:5248
    ds_read_b64_tr_b16 v[116:117], v14 offset:8960
    ds_read_b64_tr_b16 v[118:119], v14 offset:9120
    ds_read_b64_tr_b16 v[120:121], v14 offset:8992
    ds_read_b64_tr_b16 v[122:123], v14 offset:9152
    ds_read_b128 v[92:95], v13 offset:5312
    ds_read_b64_tr_b16 v[124:125], v14 offset:10240
    ds_read_b64_tr_b16 v[126:127], v14 offset:10400
    ds_read_b64_tr_b16 v[128:129], v14 offset:10272
    ds_read_b64_tr_b16 v[130:131], v14 offset:10432
    ds_read_b128 v[96:99], v13 offset:5376
    ds_read_b64_tr_b16 v[132:133], v14 offset:11520
    ds_read_b64_tr_b16 v[134:135], v14 offset:11680
    ds_read_b64_tr_b16 v[136:137], v14 offset:11552
    ds_read_b64_tr_b16 v[138:139], v14 offset:11712
    s_cbranch_scc1 KM_KVV1
    s_waitcnt lgkmcnt(15)
    v_mfma_f32_16x16x32_bf16 v[140:143], v[100:103], v[80:83], v[140:143]
    v_mfma_f32_16x16x32_bf16 v[144:147], v[104:107], v[80:83], v[144:147]
    s_waitcnt lgkmcnt(15)
    v_mfma_f32_16x16x32_bf16 v[140:143], v[108:111], v[84:87], v[140:143]
    v_mfma_f32_16x16x32_bf16 v[144:147], v[112:115], v[84:87], v[144:147]
    s_waitcnt lgkmcnt(10)
    v_mfma_f32_16x16x32_bf16 v[140:143], v[116:119], v[88:91], v[140:143]
    v_mfma_f32_16x16x32_bf16 v[144:147], v[120:123], v[88:91], v[144:147]
    s_waitcnt lgkmcnt(5)
    v_mfma_f32_16x16x32_bf16 v[140:143], v[124:127], v[92:95], v[140:143]
    v_mfma_f32_16x16x32_bf16 v[144:147], v[128:131], v[92:95], v[144:147]
    s_waitcnt lgkmcnt(0)
    v_mfma_f32_16x16x32_bf16 v[140:143], v[132:135], v[96:99], v[140:143]
    v_mfma_f32_16x16x32_bf16 v[144:147], v[136:139], v[96:99], v[144:147]
    s_branch KM_KVX1
KM_KVV1:
    s_waitcnt lgkmcnt(15)
    v_mfma_f32_16x16x32_bf16 v[140:143], v[80:83], v[100:103], v[140:143]
    v_mfma_f32_16x16x32_bf16 v[144:147], v[80:83], v[104:107], v[144:147]
    s_waitcnt lgkmcnt(15)
    v_mfma_f32_16x16x32_bf16 v[140:143], v[84:87], v[108:111], v[140:143]
    v_mfma_f32_16x16x32_bf16 v[144:147], v[84:87], v[112:115], v[144:147]
    s_waitcnt lgkmcnt(10)
    v_mfma_f32_16x16x32_bf16 v[140:143], v[88:91], v[116:119], v[140:143]
    v_mfma_f32_16x16x32_bf16 v[144:147], v[88:91], v[120:123], v[144:147]
    s_waitcnt lgkmcnt(5)
    v_mfma_f32_16x16x32_bf16 v[140:143], v[92:95], v[124:127], v[140:143]
    v_mfma_f32_16x16x32_bf16 v[144:147], v[92:95], v[128:131], v[144:147]
    s_waitcnt lgkmcnt(0)
    v_mfma_f32_16x16x32_bf16 v[140:143], v[96:99], v[132:135], v[140:143]
    v_mfma_f32_16x16x32_bf16 v[144:147], v[96:99], v[136:139], v[144:147]
KM_KVX1:
    s_waitcnt vmcnt(11)
    ds_read_b128 v[20:23], v13 offset:10240
    ds_read_b64_tr_b16 v[40:41], v14 offset:12800
    ds_read_b64_tr_b16 v[42:43], v14 offset:12960
    ds_read_b64_tr_b16 v[44:45], v14 offset:12832
    ds_read_b64_tr_b16 v[46:47], v14 offset:12992
    ds_read_b128 v[24:27], v13 offset:10304
    ds_read_b64_tr_b16 v[48:49], v14 offset:14080
    ds_read_b64_tr_b16 v[50:51], v14 offset:14240
    ds_read_b64_tr_b16 v[52:53], v14 offset:14112
    ds_read_b64_tr_b16 v[54:55], v14 offset:14272
    ds_read_b128 v[28:31], v13 offset:10368
    ds_read_b64_tr_b16 v[56:57], v14 offset:15360
    ds_read_b64_tr_b16 v[58:59], v14 offset:15520
    ds_read_b64_tr_b16 v[60:61], v14 offset:15392
    ds_read_b64_tr_b16 v[62:63], v14 offset:15552
    ds_read_b128 v[32:35], v13 offset:10432
    ds_read_b64_tr_b16 v[64:65], v14 offset:16640
    ds_read_b64_tr_b16 v[66:67], v14 offset:16800
    ds_read_b64_tr_b16 v[68:69], v14 offset:16672
    ds_read_b64_tr_b16 v[70:71], v14 offset:16832
    ds_read_b128 v[36:39], v13 offset:10496
    ds_read_b64_tr_b16 v[72:73], v14 offset:17920
    ds_read_b64_tr_b16 v[74:75], v14 offset:18080
    ds_read_b64_tr_b16 v[76:77], v14 offset:17952
    ds_read_b64_tr_b16 v[78:79], v14 offset:18112
    s_cbranch_scc1 KM_KVV2
    s_waitcnt lgkmcnt(15)
    v_mfma_f32_16x16x32_bf16 v[140:143], v[40:43], v[20:23], v[140:143]
    v_mfma_f32_16x16x32_bf16 v[144:147], v[44:47], v[20:23], v[144:147]
    s_waitcnt lgkmcnt(15)
    v_mfma_f32_16x16x32_bf16 v[140:143], v[48:51], v[24:27], v[140:143]
    v_mfma_f32_16x16x32_bf16 v[144:147], v[52:55], v[24:27], v[144:147]
    s_waitcnt lgkmcnt(10)
    v_mfma_f32_16x16x32_bf16 v[140:143], v[56:59], v[28:31], v[140:143]
    v_mfma_f32_16x16x32_bf16 v[144:147], v[60:63], v[28:31], v[144:147]
    s_waitcnt lgkmcnt(5)
    v_mfma_f32_16x16x32_bf16 v[140:143], v[64:67], v[32:35], v[140:143]
    v_mfma_f32_16x16x32_bf16 v[144:147], v[68:71], v[32:35], v[144:147]
    s_waitcnt lgkmcnt(0)
    v_mfma_f32_16x16x32_bf16 v[140:143], v[72:75], v[36:39], v[140:143]
    v_mfma_f32_16x16x32_bf16 v[144:147], v[76:79], v[36:39], v[144:147]
    s_branch KM_KVX2
KM_KVV2:
    s_waitcnt lgkmcnt(15)
    v_mfma_f32_16x16x32_bf16 v[140:143], v[20:23], v[40:43], v[140:143]
    v_mfma_f32_16x16x32_bf16 v[144:147], v[20:23], v[44:47], v[144:147]
    s_waitcnt lgkmcnt(15)
    v_mfma_f32_16x16x32_bf16 v[140:143], v[24:27], v[48:51], v[140:143]
    v_mfma_f32_16x16x32_bf16 v[144:147], v[24:27], v[52:55], v[144:147]
    s_waitcnt lgkmcnt(10)
    v_mfma_f32_16x16x32_bf16 v[140:143], v[28:31], v[56:59], v[140:143]
    v_mfma_f32_16x16x32_bf16 v[144:147], v[28:31], v[60:63], v[144:147]
    s_waitcnt lgkmcnt(5)
    v_mfma_f32_16x16x32_bf16 v[140:143], v[32:35], v[64:67], v[140:143]
    v_mfma_f32_16x16x32_bf16 v[144:147], v[32:35], v[68:71], v[144:147]
    s_waitcnt lgkmcnt(0)
    v_mfma_f32_16x16x32_bf16 v[140:143], v[36:39], v[72:75], v[140:143]
    v_mfma_f32_16x16x32_bf16 v[144:147], v[36:39], v[76:79], v[144:147]
KM_KVX2:
    s_waitcnt vmcnt(0)
    ds_read_b128 v[80:83], v13 offset:15360
    ds_read_b64_tr_b16 v[100:101], v14 offset:19200
    ds_read_b64_tr_b16 v[102:103], v14 offset:19360
    ds_read_b64_tr_b16 v[104:105], v14 offset:19232
    ds_read_b64_tr_b16 v[106:107], v14 offset:19392
    ds_read_b128 v[84:87], v13 offset:15424
    ds_read_b64_tr_b16 v[108:109], v14 offset:20480
    ds_read_b64_tr_b16 v[110:111], v14 offset:20640
    ds_read_b64_tr_b16 v[112:113], v14 offset:20512
    ds_read_b64_tr_b16 v[114:115], v14 offset:20672
    ds_read_b128 v[88:91], v13 offset:15488
    ds_read_b64_tr_b16 v[116:117], v14 offset:21760
    ds_read_b64_tr_b16 v[118:119], v14 offset:21920
    ds_read_b64_tr_b16 v[120:121], v14 offset:21792
    ds_read_b64_tr_b16 v[122:123], v14 offset:21952
    ds_read_b128 v[92:95], v13 offset:15552
    ds_read_b64_tr_b16 v[124:125], v14 offset:23040
    ds_read_b64_tr_b16 v[126:127], v14 offset:23200
    ds_read_b64_tr_b16 v[128:129], v14 offset:23072
    ds_read_b64_tr_b16 v[130:131], v14 offset:23232
    ds_read_b128 v[96:99], v13 offset:15616
    ds_read_b64_tr_b16 v[132:133], v14 offset:24320
    ds_read_b64_tr_b16 v[134:135], v14 offset:24480
    ds_read_b64_tr_b16 v[136:137], v14 offset:24352
    ds_read_b64_tr_b16 v[138:139], v14 offset:24512
    s_cbranch_scc1 KM_KVV3
    s_waitcnt lgkmcnt(15)
    v_mfma_f32_16x16x32_bf16 v[140:143], v[100:103], v[80:83], v[140:143]
    v_mfma_f32_16x16x32_bf16 v[144:147], v[104:107], v[80:83], v[144:147]
    s_waitcnt lgkmcnt(15)
    v_mfma_f32_16x16x32_bf16 v[140:143], v[108:111], v[84:87], v[140:143]
    v_mfma_f32_16x16x32_bf16 v[144:147], v[112:115], v[84:87], v[144:147]
    s_waitcnt lgkmcnt(10)
    v_mfma_f32_16x16x32_bf16 v[140:143], v[116:119], v[88:91], v[140:143]
    v_mfma_f32_16x16x32_bf16 v[144:147], v[120:123], v[88:91], v[144:147]
    s_waitcnt lgkmcnt(5)
    v_mfma_f32_16x16x32_bf16 v[140:143], v[124:127], v[92:95], v[140:143]
    v_mfma_f32_16x16x32_bf16 v[144:147], v[128:131], v[92:95], v[144:147]
    s_waitcnt lgkmcnt(0)
    v_mfma_f32_16x16x32_bf16 v[140:143], v[132:135], v[96:99], v[140:143]
    v_mfma_f32_16x16x32_bf16 v[144:147], v[136:139], v[96:99], v[144:147]
    s_branch KM_KVX3
KM_KVV3:
    s_waitcnt lgkmcnt(15)
    v_mfma_f32_16x16x32_bf16 v[140:143], v[80:83], v[100:103], v[140:143]
    v_mfma_f32_16x16x32_bf16 v[144:147], v[80:83], v[104:107], v[144:147]
    s_waitcnt lgkmcnt(15)
    v_mfma_f32_16x16x32_bf16 v[140:143], v[84:87], v[108:111], v[140:143]
    v_mfma_f32_16x16x32_bf16 v[144:147], v[84:87], v[112:115], v[144:147]
    s_waitcnt lgkmcnt(10)
    v_mfma_f32_16x16x32_bf16 v[140:143], v[88:91], v[116:119], v[140:143]
    v_mfma_f32_16x16x32_bf16 v[144:147], v[88:91], v[120:123], v[144:147]
    s_waitcnt lgkmcnt(5)
    v_mfma_f32_16x16x32_bf16 v[140:143], v[92:95], v[124:127], v[140:143]
    v_mfma_f32_16x16x32_bf16 v[144:147], v[92:95], v[128:131], v[144:147]
    s_waitcnt lgkmcnt(0)
    v_mfma_f32_16x16x32_bf16 v[140:143], v[96:99], v[132:135], v[140:143]
    v_mfma_f32_16x16x32_bf16 v[144:147], v[96:99], v[136:139], v[144:147]
KM_KVX3:
    s_nop 6
    s_bitcmp1_b32 s5, 0
    s_cbranch_scc1 KM_KV_VS
    v_mul_f32 v140, 0x3ea52b5c, v140
    v_mul_f32 v141, 0x3ea52b5c, v141
    v_mul_f32 v142, 0x3ea52b5c, v142
    v_mul_f32 v143, 0x3ea52b5c, v143
    v_mul_f32 v144, 0x3ea52b5c, v144
    v_mul_f32 v145, 0x3ea52b5c, v145
    v_mul_f32 v146, 0x3ea52b5c, v146
    v_mul_f32 v147, 0x3ea52b5c, v147
    v_cvt_pk_bf16_f32 v60, v140, v141
    v_cvt_pk_bf16_f32 v61, v142, v143
    v_cvt_pk_bf16_f32 v62, v144, v145
    v_cvt_pk_bf16_f32 v63, v146, v147
    v_lshrrev_b32 v9, 5, v5
    v_and_b32 v10, 31, v5
    v_lshlrev_b32 v8, 10, v9
    v_lshl_add_u32 v8, v10, 4, v8
    v_lshrrev_b32 v11, 1, v4
    v_lshl_add_u32 v8, v11, 9, v8
    v_and_b32 v11, 1, v4
    v_lshl_add_u32 v8, v11, 3, v8
    v_add_u32 v8, 2621440, v8
    buffer_store_dwordx2 v[60:61], v8, s[44:47], 0 offen sc1
    v_lshrrev_b32 v11, 2, v9
    v_lshlrev_b32 v11, 10, v11
    v_lshl_add_u32 v11, v10, 4, v11
    v_and_b32 v9, 3, v9
    v_lshl_add_u32 v11, v9, 2, v11
    v_add_u32 v11, 2686976, v11
    s_mov_b64 exec, 0xffff
    buffer_store_dword v62, v11, s[44:47], 0 offen sc1
    buffer_store_dword v63, v11, s[44:47], 0 offen offset:512 sc1
    s_branch KM_KV_P
KM_KV_VS:
    v_cvt_pk_bf16_f32 v60, v140, v141
    v_cvt_pk_bf16_f32 v61, v142, v143
    v_cvt_pk_bf16_f32 v62, v144, v145
    v_cvt_pk_bf16_f32 v63, v146, v147
    s_lshr_b32 s14, s6, 4
    s_mul_i32 s14, s14, 640
    s_add_u32 s14, s14, 2703360
    v_lshrrev_b32 v9, 1, v4
    v_mul_u32_u24 v9, 320, v9
    v_lshl_add_u32 v9, v3, 4, v9
    v_and_b32 v11, 1, v4
    v_lshl_add_u32 v9, v11, 3, v9
    v_cmp_gt_u32 vcc, 4, v3
    buffer_store_dwordx2 v[60:61], v9, s[44:47], s14 offen sc1
    s_mov_b64 exec, vcc
    buffer_store_dwordx2 v[62:63], v9, s[44:47], s14 offen offset:256 sc1
KM_KV_P:
    s_mov_b64 exec, -1
    s_lshr_b32 s14, s4, 2
    s_lshl_b32 s14, s14, 7
    s_add_u32 s14, s14, 11468800
    v_lshl_add_u32 v14, v2, 10, s14
    v_mov_b32 v13, 1
    s_and_b32 s14, s2, 1
    s_lshl_b32 s14, s14, 7
    v_mov_b32 v17, s14
    s_mov_b64 exec, 1
KM_GO:
    global_load_dword v18, v17, s[42:43] sc1
    s_waitcnt vmcnt(0)
    v_readfirstlane_b32 s14, v18
    s_nop 3
    s_cmp_eq_u32 s14, 0
    s_cbranch_scc1 KM_GO
    s_mov_b64 exec, 0xff
    buffer_atomic_add v13, v14, s[44:47], 0 offen sc1
    s_mov_b64 exec, -1
    s_barrier
    s_branch K2_HELPER
KM_IDLE:
    s_waitcnt lgkmcnt(0)
    s_mov_b64 s[62:63], s[40:41]
    s_mov_b64 s[40:41], s[42:43]
    s_mov_b64 s[42:43], s[62:63]
    s_sub_u32 s14, s3, 6
    s_getpc_b64 s[60:61]
CT2:
    s_and_b32 s62, s14, 3
    s_mul_i32 s62, s62, 960
    s_add_i32 s62, s62, K2_ATT-CT2
    s_max_i32 s62, s62, 0
    s_add_u32 s60, s60, s62
    s_addc_u32 s61, s61, 0
    s_load_dword s63, s[60:61], 0
    s_load_dword s63, s[60:61], 64
    s_load_dword s63, s[60:61], 128
    s_load_dword s63, s[60:61], 192
    s_load_dword s63, s[60:61], 256
    s_load_dword s63, s[60:61], 320
    s_load_dword s63, s[60:61], 384
    s_load_dword s63, s[60:61], 448
    s_load_dword s63, s[60:61], 512
    s_load_dword s63, s[60:61], 576
    s_load_dword s63, s[60:61], 640
    s_load_dword s63, s[60:61], 704
    s_load_dword s63, s[60:61], 768
    s_load_dword s63, s[60:61], 832
    s_load_dword s63, s[60:61], 896
    s_barrier
    s_barrier
    s_waitcnt lgkmcnt(0)
    s_getpc_b64 s[60:61]
CT3:
    s_and_b32 s62, s14, 3
    s_mul_i32 s62, s62, 960
    s_add_i32 s62, s62, K2_ATT+1920-CT3
    s_max_i32 s62, s62, 0
    s_add_u32 s60, s60, s62
    s_addc_u32 s61, s61, 0
    s_load_dword s63, s[60:61], 0
    s_load_dword s63, s[60:61], 64
    s_load_dword s63, s[60:61], 128
    s_load_dword s63, s[60:61], 192
    s_load_dword s63, s[60:61], 256
    s_load_dword s63, s[60:61], 320
    s_load_dword s63, s[60:61], 384
    s_load_dword s63, s[60:61], 448
    s_load_dword s63, s[60:61], 512
    s_load_dword s63, s[60:61], 576
    s_load_dword s63, s[60:61], 640
    s_load_dword s63, s[60:61], 704
    s_load_dword s63, s[60:61], 768
    s_load_dword s63, s[60:61], 832
    s_load_dword s63, s[60:61], 896
    s_waitcnt lgkmcnt(0)
    s_getpc_b64 s[60:61]
CT4:
    s_and_b32 s62, s14, 3
    s_mul_i32 s62, s62, 960
    s_add_i32 s62, s62, K2_H_B1-CT4
    s_max_i32 s62, s62, 0
    s_add_u32 s60, s60, s62
    s_addc_u32 s61, s61, 0
    s_load_dword s63, s[60:61], 0
    s_load_dword s63, s[60:61], 64
    s_load_dword s63, s[60:61], 128
    s_load_dword s63, s[60:61], 192
    s_load_dword s63, s[60:61], 256
    s_load_dword s63, s[60:61], 320
    s_load_dword s63, s[60:61], 384
    s_load_dword s63, s[60:61], 448
    s_load_dword s63, s[60:61], 512
    s_load_dword s63, s[60:61], 576
    s_load_dword s63, s[60:61], 640
    s_load_dword s63, s[60:61], 704
    s_load_dword s63, s[60:61], 768
    s_load_dword s63, s[60:61], 832
    s_load_dword s63, s[60:61], 896
    s_barrier
    s_waitcnt lgkmcnt(0)
    s_getpc_b64 s[60:61]
CT5:
    s_and_b32 s62, s14, 3
    s_mul_i32 s62, s62, 960
    s_add_i32 s62, s62, K2_H_B1+1920-CT5
    s_max_i32 s62, s62, 0
    s_add_u32 s60, s60, s62
    s_addc_u32 s61, s61, 0
    s_load_dword s63, s[60:61], 0
    s_load_dword s63, s[60:61], 64
    s_load_dword s63, s[60:61], 128
    s_load_dword s63, s[60:61], 192
    s_load_dword s63, s[60:61], 256
    s_load_dword s63, s[60:61], 320
    s_load_dword s63, s[60:61], 384
    s_load_dword s63, s[60:61], 448
    s_load_dword s63, s[60:61], 512
    s_load_dword s63, s[60:61], 576
    s_load_dword s63, s[60:61], 640
    s_load_dword s63, s[60:61], 704
    s_load_dword s63, s[60:61], 768
    s_load_dword s63, s[60:61], 832
    s_load_dword s63, s[60:61], 896
    s_barrier
    v_lshlrev_b32 v8, 2, v0
    v_add_u32 v8, 10240, v8
    v_add_u32 v9, -6, v0
    v_lshrrev_b32 v10, 2, v0
    v_cmp_eq_u32 vcc, 2, v10
    s_nop 1
    v_cndmask_b32 v9, 0, v9, vcc
    ds_write_b32 v8, v9
    s_branch K2_ATT
KM_LOADER:
    v_add_u32 v13, 0, v2
    v_mul_u32_u24 v14, 6554, v13
    v_lshrrev_b32 v14, 16, v14
    v_mul_u32_u24 v15, 10, v14
    v_sub_u32 v15, v13, v15
    v_bfe_u32 v16, v14, 2, 2
    v_lshlrev_b32 v16, 3, v16
    v_bfe_u32 v17, v14, 4, 1
    v_lshl_add_u32 v16, v17, 2, v16
    v_and_b32 v17, 3, v14
    v_add_u32 v16, v16, v17
    v_mul_u32_u24 v16, 1280, v16
    v_lshl_add_u32 v16, v15, 4, v16
    v_add_u32 v8, s8, v16
    v_add_u32 v13, 64, v2
    v_mul_u32_u24 v14, 6554, v13
    v_lshrrev_b32 v14, 16, v14
    v_mul_u32_u24 v15, 10, v14
    v_sub_u32 v15, v13, v15
    v_bfe_u32 v16, v14, 2, 2
    v_lshlrev_b32 v16, 3, v16
    v_bfe_u32 v17, v14, 4, 1
    v_lshl_add_u32 v16, v17, 2, v16
    v_and_b32 v17, 3, v14
    v_add_u32 v16, v16, v17
    v_mul_u32_u24 v16, 1280, v16
    v_lshl_add_u32 v16, v15, 4, v16
    v_add_u32 v9, s8, v16
    v_add_u32 v13, 128, v2
    v_mul_u32_u24 v14, 6554, v13
    v_lshrrev_b32 v14, 16, v14
    v_mul_u32_u24 v15, 10, v14
    v_sub_u32 v15, v13, v15
    v_bfe_u32 v16, v14, 2, 2
    v_lshlrev_b32 v16, 3, v16
    v_bfe_u32 v17, v14, 4, 1
    v_lshl_add_u32 v16, v17, 2, v16
    v_and_b32 v17, 3, v14
    v_add_u32 v16, v16, v17
    v_mul_u32_u24 v16, 1280, v16
    v_lshl_add_u32 v16, v15, 4, v16
    v_add_u32 v10, s8, v16
    v_add_u32 v13, 192, v2
    v_mul_u32_u24 v14, 6554, v13
    v_lshrrev_b32 v14, 16, v14
    v_mul_u32_u24 v15, 10, v14
    v_sub_u32 v15, v13, v15
    v_bfe_u32 v16, v14, 2, 2
    v_lshlrev_b32 v16, 3, v16
    v_bfe_u32 v17, v14, 4, 1
    v_lshl_add_u32 v16, v17, 2, v16
    v_and_b32 v17, 3, v14
    v_add_u32 v16, v16, v17
    v_mul_u32_u24 v16, 1280, v16
    v_lshl_add_u32 v16, v15, 4, v16
    v_add_u32 v11, s8, v16
    v_add_u32 v13, 256, v2
    v_mul_u32_u24 v14, 6554, v13
    v_lshrrev_b32 v14, 16, v14
    v_mul_u32_u24 v15, 10, v14
    v_sub_u32 v15, v13, v15
    v_bfe_u32 v16, v14, 2, 2
    v_lshlrev_b32 v16, 3, v16
    v_bfe_u32 v17, v14, 4, 1
    v_lshl_add_u32 v16, v17, 2, v16
    v_and_b32 v17, 3, v14
    v_add_u32 v16, v16, v17
    v_mul_u32_u24 v16, 1280, v16
    v_lshl_add_u32 v16, v15, 4, v16
    v_add_u32 v12, s8, v16
    s_sub_u32 s6, s3, 4
    s_mul_i32 s12, s6, 5120
    s_mul_i32 s6, s6, 40960
    s_mul_i32 s10, s7, 409600
    s_xor_b32 s11, s10, 409600
    s_add_u32 s10, s10, s6
    s_add_u32 s11, s11, s6
    s_waitcnt lgkmcnt(0)
    s_mov_b64 s[62:63], s[40:41]
    s_mov_b64 s[40:41], s[42:43]
    s_mov_b64 s[42:43], s[62:63]
    s_mov_b32 s48, s30
    s_and_b32 s49, s31, 0xffff
    s_mov_b32 s50, 819200
    s_mov_b32 s51, 0x20000
    s_barrier
    s_lshr_b32 s15, s4, 1
    s_mul_i32 s13, s15, 52
    s_lshr_b32 s13, s13, 8
    s_mul_i32 s13, s13, 5
    s_sub_u32 s15, s15, s13
    s_mul_i32 s13, s15, 10240
    s_add_u32 s13, s13, s12
    s_mul_i32 s14, s15, 81920
    s_add_u32 s14, s14, s10
    s_add_u32 s15, s15, 1
    s_cmp_eq_u32 s15, 5
    s_cselect_b32 s15, 0, s15
    s_add_u32 m0, s13, 0
    s_nop 0
    buffer_load_dwordx4 v8, s[48:51], s14 offen lds
    s_add_u32 m0, s13, 1024
    s_nop 0
    buffer_load_dwordx4 v9, s[48:51], s14 offen lds
    s_add_u32 m0, s13, 2048
    s_nop 0
    buffer_load_dwordx4 v10, s[48:51], s14 offen lds
    s_add_u32 m0, s13, 3072
    s_nop 0
    buffer_load_dwordx4 v11, s[48:51], s14 offen lds
    s_add_u32 m0, s13, 4096
    s_nop 0
    buffer_load_dwordx4 v12, s[48:51], s14 offen lds
    s_mul_i32 s13, s15, 10240
    s_add_u32 s13, s13, s12
    s_mul_i32 s14, s15, 81920
    s_add_u32 s14, s14, s10
    s_add_u32 s15, s15, 1
    s_cmp_eq_u32 s15, 5
    s_cselect_b32 s15, 0, s15
    s_add_u32 m0, s13, 0
    s_nop 0
    buffer_load_dwordx4 v8, s[48:51], s14 offen lds
    s_add_u32 m0, s13, 1024
    s_nop 0
    buffer_load_dwordx4 v9, s[48:51], s14 offen lds
    s_add_u32 m0, s13, 2048
    s_nop 0
    buffer_load_dwordx4 v10, s[48:51], s14 offen lds
    s_add_u32 m0, s13, 3072
    s_nop 0
    buffer_load_dwordx4 v11, s[48:51], s14 offen lds
    s_add_u32 m0, s13, 4096
    s_nop 0
    buffer_load_dwordx4 v12, s[48:51], s14 offen lds
    s_mul_i32 s13, s15, 10240
    s_add_u32 s13, s13, s12
    s_mul_i32 s14, s15, 81920
    s_add_u32 s14, s14, s10
    s_add_u32 s15, s15, 1
    s_cmp_eq_u32 s15, 5
    s_cselect_b32 s15, 0, s15
    s_add_u32 m0, s13, 0
    s_nop 0
    buffer_load_dwordx4 v8, s[48:51], s14 offen lds
    s_add_u32 m0, s13, 1024
    s_nop 0
    buffer_load_dwordx4 v9, s[48:51], s14 offen lds
    s_add_u32 m0, s13, 2048
    s_nop 0
    buffer_load_dwordx4 v10, s[48:51], s14 offen lds
    s_add_u32 m0, s13, 3072
    s_nop 0
    buffer_load_dwordx4 v11, s[48:51], s14 offen lds
    s_add_u32 m0, s13, 4096
    s_nop 0
    buffer_load_dwordx4 v12, s[48:51], s14 offen lds
    s_barrier
    s_mul_i32 s13, s15, 10240
    s_add_u32 s13, s13, s12
    s_mul_i32 s14, s15, 81920
    s_add_u32 s14, s14, s10
    s_add_u32 s15, s15, 1
    s_cmp_eq_u32 s15, 5
    s_cselect_b32 s15, 0, s15
    s_add_u32 m0, s13, 0
    s_nop 0
    buffer_load_dwordx4 v8, s[48:51], s14 offen lds
    s_add_u32 m0, s13, 1024
    s_nop 0
    buffer_load_dwordx4 v9, s[48:51], s14 offen lds
    s_add_u32 m0, s13, 2048
    s_nop 0
    buffer_load_dwordx4 v10, s[48:51], s14 offen lds
    s_add_u32 m0, s13, 3072
    s_nop 0
    buffer_load_dwordx4 v11, s[48:51], s14 offen lds
    s_add_u32 m0, s13, 4096
    s_nop 0
    buffer_load_dwordx4 v12, s[48:51], s14 offen lds
    s_mul_i32 s13, s15, 10240
    s_add_u32 s13, s13, s12
    s_mul_i32 s14, s15, 81920
    s_add_u32 s14, s14, s10
    s_add_u32 s15, s15, 1
    s_cmp_eq_u32 s15, 5
    s_cselect_b32 s15, 0, s15
    s_add_u32 m0, s13, 0
    s_nop 0
    buffer_load_dwordx4 v8, s[48:51], s14 offen lds
    s_add_u32 m0, s13, 1024
    s_nop 0
    buffer_load_dwordx4 v9, s[48:51], s14 offen lds
    s_add_u32 m0, s13, 2048
    s_nop 0
    buffer_load_dwordx4 v10, s[48:51], s14 offen lds
    s_add_u32 m0, s13, 3072
    s_nop 0
    buffer_load_dwordx4 v11, s[48:51], s14 offen lds
    s_add_u32 m0, s13, 4096
    s_nop 0
    buffer_load_dwordx4 v12, s[48:51], s14 offen lds
    s_add_u32 m0, s12, 51200
    s_add_u32 s14, s11, 0
    buffer_load_dwordx4 v8, s[48:51], s14 offen lds
    s_add_u32 m0, s12, 52224
    s_nop 0
    buffer_load_dwordx4 v9, s[48:51], s14 offen lds
    s_add_u32 m0, s12, 53248
    s_nop 0
    buffer_load_dwordx4 v10, s[48:51], s14 offen lds
    s_add_u32 m0, s12, 54272
    s_nop 0
    buffer_load_dwordx4 v11, s[48:51], s14 offen lds
    s_add_u32 m0, s12, 55296
    s_nop 0
    buffer_load_dwordx4 v12, s[48:51], s14 offen lds
    s_waitcnt vmcnt(5)
    s_barrier
    s_add_u32 m0, s12, 61440
    s_add_u32 s14, s11, 81920
    buffer_load_dwordx4 v8, s[48:51], s14 offen lds
    s_add_u32 m0, s12, 62464
    s_nop 0
    buffer_load_dwordx4 v9, s[48:51], s14 offen lds
    s_add_u32 m0, s12, 63488
    s_nop 0
    buffer_load_dwordx4 v10, s[48:51], s14 offen lds
    s_add_u32 m0, s12, 64512
    s_nop 0
    buffer_load_dwordx4 v11, s[48:51], s14 offen lds
    s_add_u32 m0, s12, 65536
    s_nop 0
    buffer_load_dwordx4 v12, s[48:51], s14 offen lds
    s_add_u32 m0, s12, 71680
    s_add_u32 s14, s11, 163840
    buffer_load_dwordx4 v8, s[48:51], s14 offen lds
    s_add_u32 m0, s12, 72704
    s_nop 0
    buffer_load_dwordx4 v9, s[48:51], s14 offen lds
    s_add_u32 m0, s12, 73728
    s_nop 0
    buffer_load_dwordx4 v10, s[48:51], s14 offen lds
    s_add_u32 m0, s12, 74752
    s_nop 0
    buffer_load_dwordx4 v11, s[48:51], s14 offen lds
    s_add_u32 m0, s12, 75776
    s_nop 0
    buffer_load_dwordx4 v12, s[48:51], s14 offen lds
    s_add_u32 m0, s12, 81920
    s_add_u32 s14, s11, 245760
    buffer_load_dwordx4 v8, s[48:51], s14 offen lds
    s_add_u32 m0, s12, 82944
    s_nop 0
    buffer_load_dwordx4 v9, s[48:51], s14 offen lds
    s_add_u32 m0, s12, 83968
    s_nop 0
    buffer_load_dwordx4 v10, s[48:51], s14 offen lds
    s_add_u32 m0, s12, 84992
    s_nop 0
    buffer_load_dwordx4 v11, s[48:51], s14 offen lds
    s_add_u32 m0, s12, 86016
    s_nop 0
    buffer_load_dwordx4 v12, s[48:51], s14 offen lds
    s_add_u32 m0, s12, 92160
    s_add_u32 s14, s11, 327680
    buffer_load_dwordx4 v8, s[48:51], s14 offen lds
    s_add_u32 m0, s12, 93184
    s_nop 0
    buffer_load_dwordx4 v9, s[48:51], s14 offen lds
    s_add_u32 m0, s12, 94208
    s_nop 0
    buffer_load_dwordx4 v10, s[48:51], s14 offen lds
    s_add_u32 m0, s12, 95232
    s_nop 0
    buffer_load_dwordx4 v11, s[48:51], s14 offen lds
    s_add_u32 m0, s12, 96256
    s_nop 0
    buffer_load_dwordx4 v12, s[48:51], s14 offen lds
    s_waitcnt vmcnt(0)
    s_mov_b32 s44, s40
    s_and_b32 s45, s41, 0xffff
    s_mov_b32 s46, 11513856
    s_mov_b32 s47, 0x20000
    s_cmp_eq_u32 s3, 5
    s_cbranch_scc0 KM_LD_C
    s_and_b32 s13, s2, 7
    s_lshl_b32 s13, s13, 10
    s_add_u32 s13, s13, 11468800
    v_lshlrev_b32 v8, 7, v2
    s_mov_b64 exec, 0xff
KM_LD_P:
    buffer_load_dword v9, v8, s[44:47], s13 offen sc1
    s_waitcnt vmcnt(0)
    v_cmp_ne_u32 vcc, 32, v9
    s_nop 3
    s_cbranch_vccz KM_LD_Q
    s_sleep 8
    s_branch KM_LD_P
KM_LD_Q:
    s_mov_b64 exec, -1
KM_LD_C:
    s_barrier
    s_branch K2_ATT
KM_CONS:
    s_setprio 2
    s_lshl_b32 s6, s4, 6
    s_lshl_b32 s9, s3, 4
    s_add_u32 s6, s6, s9
    s_mul_i32 s10, s6, 1280
    s_mul_i32 s9, s7, 640
    s_add_u32 s11, s10, s9
    s_xor_b32 s9, s9, 640
    s_add_u32 s12, s10, s9
    v_add_u32 v13, 0, v2
    v_mul_u32_u24 v14, 1639, v13
    v_lshrrev_b32 v14, 16, v14
    v_lshrrev_b32 v15, 1, v14
    v_xor_b32 v13, v13, v15
    v_mul_u32_u24 v14, 640, v14
    v_lshl_add_u32 v8, v13, 4, v14
    v_xor_b32 v132, 64, v8
    v_add_u32 v13, 64, v2
    v_mul_u32_u24 v14, 1639, v13
    v_lshrrev_b32 v14, 16, v14
    v_lshrrev_b32 v15, 1, v14
    v_xor_b32 v13, v13, v15
    v_mul_u32_u24 v14, 640, v14
    v_lshl_add_u32 v9, v13, 4, v14
    v_xor_b32 v133, 64, v9
    v_add_u32 v13, 128, v2
    v_mul_u32_u24 v14, 1639, v13
    v_lshrrev_b32 v14, 16, v14
    v_lshrrev_b32 v15, 1, v14
    v_xor_b32 v13, v13, v15
    v_mul_u32_u24 v14, 640, v14
    v_lshl_add_u32 v10, v13, 4, v14
    v_xor_b32 v134, 64, v10
    v_add_u32 v13, 192, v2
    v_mul_u32_u24 v14, 1639, v13
    v_lshrrev_b32 v14, 16, v14
    v_lshrrev_b32 v15, 1, v14
    v_xor_b32 v13, v13, v15
    v_mul_u32_u24 v14, 640, v14
    v_lshl_add_u32 v11, v13, 4, v14
    v_xor_b32 v135, 64, v11
    v_add_u32 v13, 256, v2
    v_mul_u32_u24 v14, 1639, v13
    v_lshrrev_b32 v14, 16, v14
    v_lshrrev_b32 v15, 1, v14
    v_xor_b32 v13, v13, v15
    v_mul_u32_u24 v14, 640, v14
    v_lshl_add_u32 v12, v13, 4, v14
    v_xor_b32 v136, 64, v12
    s_mul_i32 s13, s3, 10240
    s_add_u32 s13, s13, 122880
    s_waitcnt lgkmcnt(0)
    s_mov_b64 s[62:63], s[40:41]
    s_mov_b64 s[40:41], s[42:43]
    s_mov_b64 s[42:43], s[62:63]
    s_mov_b32 s44, s28
    s_and_b32 s45, s29, 0xffff
    s_mov_b32 s46, 2621440
    s_mov_b32 s47, 0x20000
    s_barrier
    s_barrier
    s_add_u32 s15, s11, 10240
    s_add_u32 m0, s13, 0
    s_nop 0
    buffer_load_dwordx4 v8, s[44:47], s11 offen lds
    s_add_u32 m0, s13, 1024
    s_nop 0
    buffer_load_dwordx4 v9, s[44:47], s11 offen lds
    s_add_u32 m0, s13, 2048
    s_nop 0
    buffer_load_dwordx4 v10, s[44:47], s11 offen lds
    s_add_u32 m0, s13, 3072
    s_nop 0
    buffer_load_dwordx4 v11, s[44:47], s11 offen lds
    s_add_u32 m0, s13, 4096
    s_nop 0
    buffer_load_dwordx4 v12, s[44:47], s11 offen lds
    s_add_u32 m0, s13, 5120
    s_nop 0
    buffer_load_dwordx4 v132, s[44:47], s15 offen lds
    s_add_u32 m0, s13, 6144
    s_nop 0
    buffer_load_dwordx4 v133, s[44:47], s15 offen lds
    s_add_u32 m0, s13, 7168
    s_nop 0
    buffer_load_dwordx4 v134, s[44:47], s15 offen lds
    s_add_u32 m0, s13, 8192
    s_nop 0
    buffer_load_dwordx4 v135, s[44:47], s15 offen lds
    s_add_u32 m0, s13, 9216
    s_nop 0
    buffer_load_dwordx4 v136, s[44:47], s15 offen lds
    v_and_b32 v3, 15, v2
    v_lshrrev_b32 v4, 4, v2
    v_lshrrev_b32 v16, 2, v2
    v_and_b32 v17, 3, v2
    v_mul_u32_u24 v13, 160, v16
    v_mad_u32_u24 v13, v17, 40, v13
    v_add_u32 v14, 51200, v13
    v_lshrrev_b32 v17, 1, v3
    v_xor_b32 v17, v17, v4
    v_mul_u32_u24 v16, 640, v3
    v_lshl_add_u32 v16, v17, 4, v16
    v_add_u32 v16, s13, v16
    v_xor_b32 v17, 64, v16
    v_bfe_u32 v5, v2, 3, 1
    v_mul_u32_u24 v5, 1280, v5
    s_mul_i32 s14, s3, 2560
    v_add_u32 v5, s14, v5
    v_and_b32 v6, 7, v2
    v_lshl_add_u32 v6, v4, 3, v6
    v_lshl_add_u32 v7, v6, 3, v5
    v_lshl_add_u32 v6, v6, 4, v5
    v_mov_b64 v[60:61], 0
    v_mov_b64 v[62:63], 0
    v_mov_b64 v[64:65], 0
    v_mov_b64 v[66:67], 0
    v_mov_b64 v[68:69], 0
    v_mov_b64 v[70:71], 0
    v_mov_b64 v[72:73], 0
    v_mov_b64 v[74:75], 0
    v_mov_b64 v[76:77], 0
    v_mov_b64 v[78:79], 0
    s_getpc_b64 s[60:61]
CT6:
    s_and_b32 s62, s3, 3
    s_mul_i32 s62, s62, 768
    s_add_i32 s62, s62, KM_GEMM-CT6
    s_max_i32 s62, s62, 0
    s_add_u32 s60, s60, s62
    s_addc_u32 s61, s61, 0
    s_load_dword s63, s[60:61], 0
    s_load_dword s63, s[60:61], 64
    s_load_dword s63, s[60:61], 128
    s_load_dword s63, s[60:61], 192
    s_load_dword s63, s[60:61], 256
    s_load_dword s63, s[60:61], 320
    s_load_dword s63, s[60:61], 384
    s_load_dword s63, s[60:61], 448
    s_load_dword s63, s[60:61], 512
    s_load_dword s63, s[60:61], 576
    s_load_dword s63, s[60:61], 640
    s_load_dword s63, s[60:61], 704
    s_waitcnt vmcnt(0)
    ds_read_b128 v[20:23], v16 offset:0
    ds_read_b128 v[24:27], v17 offset:0
    ds_read_b128 v[28:31], v16 offset:128
    ds_read_b128 v[32:35], v17 offset:128
    ds_read_b128 v[36:39], v16 offset:256
    ds_read_b128 v[40:43], v17 offset:256
    ds_read_b128 v[44:47], v16 offset:384
    ds_read_b128 v[48:51], v17 offset:384
    ds_read_b128 v[52:55], v16 offset:512
    ds_read_b128 v[56:59], v17 offset:512
    s_waitcnt lgkmcnt(0)
    s_barrier
    s_add_u32 s15, s12, 10240
    s_add_u32 m0, s13, 0
    s_nop 0
    buffer_load_dwordx4 v8, s[44:47], s12 offen lds
    s_add_u32 m0, s13, 1024
    s_nop 0
    buffer_load_dwordx4 v9, s[44:47], s12 offen lds
    s_add_u32 m0, s13, 2048
    s_nop 0
    buffer_load_dwordx4 v10, s[44:47], s12 offen lds
    s_add_u32 m0, s13, 3072
    s_nop 0
    buffer_load_dwordx4 v11, s[44:47], s12 offen lds
    s_add_u32 m0, s13, 4096
    s_nop 0
    buffer_load_dwordx4 v12, s[44:47], s12 offen lds
    s_add_u32 m0, s13, 5120
    s_nop 0
    buffer_load_dwordx4 v132, s[44:47], s15 offen lds
    s_add_u32 m0, s13, 6144
    s_nop 0
    buffer_load_dwordx4 v133, s[44:47], s15 offen lds
    s_add_u32 m0, s13, 7168
    s_nop 0
    buffer_load_dwordx4 v134, s[44:47], s15 offen lds
    s_add_u32 m0, s13, 8192
    s_nop 0
    buffer_load_dwordx4 v135, s[44:47], s15 offen lds
    s_add_u32 m0, s13, 9216
    s_nop 0
    buffer_load_dwordx4 v136, s[44:47], s15 offen lds
KM_GEMM:
    ds_read_b64_tr_b16 v[84:85], v13 offset:0
    ds_read_b64_tr_b16 v[86:87], v13 offset:2560
    ds_read_b64_tr_b16 v[88:89], v13 offset:8
    ds_read_b64_tr_b16 v[90:91], v13 offset:2568
    ds_read_b64_tr_b16 v[92:93], v13 offset:16
    ds_read_b64_tr_b16 v[94:95], v13 offset:2576
    ds_read_b64_tr_b16 v[96:97], v13 offset:24
    ds_read_b64_tr_b16 v[98:99], v13 offset:2584
    ds_read_b64_tr_b16 v[100:101], v13 offset:32
    ds_read_b64_tr_b16 v[102:103], v13 offset:2592
    s_waitcnt lgkmcnt(0)
    ds_read_b64_tr_b16 v[104:105], v13 offset:5120
    ds_read_b64_tr_b16 v[106:107], v13 offset:7680
    ds_read_b64_tr_b16 v[108:109], v13 offset:5128
    ds_read_b64_tr_b16 v[110:111], v13 offset:7688
    ds_read_b64_tr_b16 v[112:113], v13 offset:5136
    v_mfma_f32_16x16x32_bf16 v[60:63], v[84:87], v[20:23], v[60:63]
    ds_read_b64_tr_b16 v[114:115], v13 offset:7696
    ds_read_b64_tr_b16 v[116:117], v13 offset:5144
    v_mfma_f32_16x16x32_bf16 v[64:67], v[88:91], v[20:23], v[64:67]
    ds_read_b64_tr_b16 v[118:119], v13 offset:7704
    ds_read_b64_tr_b16 v[120:121], v13 offset:5152
    v_mfma_f32_16x16x32_bf16 v[68:71], v[92:95], v[20:23], v[68:71]
    ds_read_b64_tr_b16 v[122:123], v13 offset:7712
    v_mfma_f32_16x16x32_bf16 v[72:75], v[96:99], v[20:23], v[72:75]
    v_mfma_f32_16x16x32_bf16 v[76:79], v[100:103], v[20:23], v[76:79]
    s_waitcnt lgkmcnt(0)
    ds_read_b64_tr_b16 v[84:85], v13 offset:10240
    ds_read_b64_tr_b16 v[86:87], v13 offset:12800
    ds_read_b64_tr_b16 v[88:89], v13 offset:10248
    ds_read_b64_tr_b16 v[90:91], v13 offset:12808
    ds_read_b64_tr_b16 v[92:93], v13 offset:10256
    v_mfma_f32_16x16x32_bf16 v[60:63], v[104:107], v[24:27], v[60:63]
    ds_read_b64_tr_b16 v[94:95], v13 offset:12816
    ds_read_b64_tr_b16 v[96:97], v13 offset:10264
    v_mfma_f32_16x16x32_bf16 v[64:67], v[108:111], v[24:27], v[64:67]
    ds_read_b64_tr_b16 v[98:99], v13 offset:12824
    ds_read_b64_tr_b16 v[100:101], v13 offset:10272
    v_mfma_f32_16x16x32_bf16 v[68:71], v[112:115], v[24:27], v[68:71]
    ds_read_b64_tr_b16 v[102:103], v13 offset:12832
    v_mfma_f32_16x16x32_bf16 v[72:75], v[116:119], v[24:27], v[72:75]
    v_mfma_f32_16x16x32_bf16 v[76:79], v[120:123], v[24:27], v[76:79]
    s_waitcnt lgkmcnt(0)
    ds_read_b64_tr_b16 v[104:105], v13 offset:15360
    ds_read_b64_tr_b16 v[106:107], v13 offset:17920
    ds_read_b64_tr_b16 v[108:109], v13 offset:15368
    ds_read_b64_tr_b16 v[110:111], v13 offset:17928
    ds_read_b64_tr_b16 v[112:113], v13 offset:15376
    v_mfma_f32_16x16x32_bf16 v[60:63], v[84:87], v[28:31], v[60:63]
    ds_read_b64_tr_b16 v[114:115], v13 offset:17936
    ds_read_b64_tr_b16 v[116:117], v13 offset:15384
    v_mfma_f32_16x16x32_bf16 v[64:67], v[88:91], v[28:31], v[64:67]
    ds_read_b64_tr_b16 v[118:119], v13 offset:17944
    ds_read_b64_tr_b16 v[120:121], v13 offset:15392
    v_mfma_f32_16x16x32_bf16 v[68:71], v[92:95], v[28:31], v[68:71]
    ds_read_b64_tr_b16 v[122:123], v13 offset:17952
    v_mfma_f32_16x16x32_bf16 v[72:75], v[96:99], v[28:31], v[72:75]
    v_mfma_f32_16x16x32_bf16 v[76:79], v[100:103], v[28:31], v[76:79]
    s_waitcnt lgkmcnt(0)
    ds_read_b64_tr_b16 v[84:85], v13 offset:20480
    ds_read_b64_tr_b16 v[86:87], v13 offset:23040
    ds_read_b64_tr_b16 v[88:89], v13 offset:20488
    ds_read_b64_tr_b16 v[90:91], v13 offset:23048
    ds_read_b64_tr_b16 v[92:93], v13 offset:20496
    v_mfma_f32_16x16x32_bf16 v[60:63], v[104:107], v[32:35], v[60:63]
    ds_read_b64_tr_b16 v[94:95], v13 offset:23056
    ds_read_b64_tr_b16 v[96:97], v13 offset:20504
    v_mfma_f32_16x16x32_bf16 v[64:67], v[108:111], v[32:35], v[64:67]
    ds_read_b64_tr_b16 v[98:99], v13 offset:23064
    ds_read_b64_tr_b16 v[100:101], v13 offset:20512
    v_mfma_f32_16x16x32_bf16 v[68:71], v[112:115], v[32:35], v[68:71]
    ds_read_b64_tr_b16 v[102:103], v13 offset:23072
    v_mfma_f32_16x16x32_bf16 v[72:75], v[116:119], v[32:35], v[72:75]
    v_mfma_f32_16x16x32_bf16 v[76:79], v[120:123], v[32:35], v[76:79]
    s_waitcnt lgkmcnt(0)
    ds_read_b64_tr_b16 v[104:105], v13 offset:25600
    ds_read_b64_tr_b16 v[106:107], v13 offset:28160
    ds_read_b64_tr_b16 v[108:109], v13 offset:25608
    ds_read_b64_tr_b16 v[110:111], v13 offset:28168
    ds_read_b64_tr_b16 v[112:113], v13 offset:25616
    v_mfma_f32_16x16x32_bf16 v[60:63], v[84:87], v[36:39], v[60:63]
    ds_read_b64_tr_b16 v[114:115], v13 offset:28176
    ds_read_b64_tr_b16 v[116:117], v13 offset:25624
    v_mfma_f32_16x16x32_bf16 v[64:67], v[88:91], v[36:39], v[64:67]
    ds_read_b64_tr_b16 v[118:119], v13 offset:28184
    ds_read_b64_tr_b16 v[120:121], v13 offset:25632
    v_mfma_f32_16x16x32_bf16 v[68:71], v[92:95], v[36:39], v[68:71]
    ds_read_b64_tr_b16 v[122:123], v13 offset:28192
    v_mfma_f32_16x16x32_bf16 v[72:75], v[96:99], v[36:39], v[72:75]
    v_mfma_f32_16x16x32_bf16 v[76:79], v[100:103], v[36:39], v[76:79]
    s_waitcnt lgkmcnt(0)
    ds_read_b64_tr_b16 v[84:85], v13 offset:30720
    ds_read_b64_tr_b16 v[86:87], v13 offset:33280
    ds_read_b64_tr_b16 v[88:89], v13 offset:30728
    ds_read_b64_tr_b16 v[90:91], v13 offset:33288
    ds_read_b64_tr_b16 v[92:93], v13 offset:30736
    v_mfma_f32_16x16x32_bf16 v[60:63], v[104:107], v[40:43], v[60:63]
    ds_read_b64_tr_b16 v[94:95], v13 offset:33296
    ds_read_b64_tr_b16 v[96:97], v13 offset:30744
    v_mfma_f32_16x16x32_bf16 v[64:67], v[108:111], v[40:43], v[64:67]
    ds_read_b64_tr_b16 v[98:99], v13 offset:33304
    ds_read_b64_tr_b16 v[100:101], v13 offset:30752
    v_mfma_f32_16x16x32_bf16 v[68:71], v[112:115], v[40:43], v[68:71]
    ds_read_b64_tr_b16 v[102:103], v13 offset:33312
    v_mfma_f32_16x16x32_bf16 v[72:75], v[116:119], v[40:43], v[72:75]
    v_mfma_f32_16x16x32_bf16 v[76:79], v[120:123], v[40:43], v[76:79]
    s_waitcnt lgkmcnt(0)
    ds_read_b64_tr_b16 v[104:105], v13 offset:35840
    ds_read_b64_tr_b16 v[106:107], v13 offset:38400
    ds_read_b64_tr_b16 v[108:109], v13 offset:35848
    ds_read_b64_tr_b16 v[110:111], v13 offset:38408
    ds_read_b64_tr_b16 v[112:113], v13 offset:35856
    v_mfma_f32_16x16x32_bf16 v[60:63], v[84:87], v[44:47], v[60:63]
    ds_read_b64_tr_b16 v[114:115], v13 offset:38416
    ds_read_b64_tr_b16 v[116:117], v13 offset:35864
    v_mfma_f32_16x16x32_bf16 v[64:67], v[88:91], v[44:47], v[64:67]
    ds_read_b64_tr_b16 v[118:119], v13 offset:38424
    ds_read_b64_tr_b16 v[120:121], v13 offset:35872
    v_mfma_f32_16x16x32_bf16 v[68:71], v[92:95], v[44:47], v[68:71]
    ds_read_b64_tr_b16 v[122:123], v13 offset:38432
    v_mfma_f32_16x16x32_bf16 v[72:75], v[96:99], v[44:47], v[72:75]
    v_mfma_f32_16x16x32_bf16 v[76:79], v[100:103], v[44:47], v[76:79]
    s_waitcnt lgkmcnt(0)
    ds_read_b64_tr_b16 v[84:85], v13 offset:40960
    ds_read_b64_tr_b16 v[86:87], v13 offset:43520
    ds_read_b64_tr_b16 v[88:89], v13 offset:40968
    ds_read_b64_tr_b16 v[90:91], v13 offset:43528
    ds_read_b64_tr_b16 v[92:93], v13 offset:40976
    v_mfma_f32_16x16x32_bf16 v[60:63], v[104:107], v[48:51], v[60:63]
    ds_read_b64_tr_b16 v[94:95], v13 offset:43536
    ds_read_b64_tr_b16 v[96:97], v13 offset:40984
    v_mfma_f32_16x16x32_bf16 v[64:67], v[108:111], v[48:51], v[64:67]
    ds_read_b64_tr_b16 v[98:99], v13 offset:43544
    ds_read_b64_tr_b16 v[100:101], v13 offset:40992
    v_mfma_f32_16x16x32_bf16 v[68:71], v[112:115], v[48:51], v[68:71]
    ds_read_b64_tr_b16 v[102:103], v13 offset:43552
    v_mfma_f32_16x16x32_bf16 v[72:75], v[116:119], v[48:51], v[72:75]
    v_mfma_f32_16x16x32_bf16 v[76:79], v[120:123], v[48:51], v[76:79]
    s_waitcnt lgkmcnt(0)
    ds_read_b64_tr_b16 v[104:105], v13 offset:46080
    ds_read_b64_tr_b16 v[106:107], v13 offset:48640
    ds_read_b64_tr_b16 v[108:109], v13 offset:46088
    ds_read_b64_tr_b16 v[110:111], v13 offset:48648
    ds_read_b64_tr_b16 v[112:113], v13 offset:46096
    v_mfma_f32_16x16x32_bf16 v[60:63], v[84:87], v[52:55], v[60:63]
    ds_read_b64_tr_b16 v[114:115], v13 offset:48656
    ds_read_b64_tr_b16 v[116:117], v13 offset:46104
    v_mfma_f32_16x16x32_bf16 v[64:67], v[88:91], v[52:55], v[64:67]
    ds_read_b64_tr_b16 v[118:119], v13 offset:48664
    ds_read_b64_tr_b16 v[120:121], v13 offset:46112
    v_mfma_f32_16x16x32_bf16 v[68:71], v[92:95], v[52:55], v[68:71]
    ds_read_b64_tr_b16 v[122:123], v13 offset:48672
    v_mfma_f32_16x16x32_bf16 v[72:75], v[96:99], v[52:55], v[72:75]
    v_mfma_f32_16x16x32_bf16 v[76:79], v[100:103], v[52:55], v[76:79]
    s_waitcnt lgkmcnt(0)
    s_waitcnt vmcnt(0)
    s_barrier
    ds_read_b128 v[20:23], v16 offset:0
    ds_read_b64_tr_b16 v[84:85], v14 offset:0
    ds_read_b64_tr_b16 v[86:87], v14 offset:2560
    ds_read_b64_tr_b16 v[88:89], v14 offset:8
    ds_read_b64_tr_b16 v[90:91], v14 offset:2568
    v_mfma_f32_16x16x32_bf16 v[60:63], v[104:107], v[56:59], v[60:63]
    ds_read_b64_tr_b16 v[92:93], v14 offset:16
    ds_read_b64_tr_b16 v[94:95], v14 offset:2576
    v_mfma_f32_16x16x32_bf16 v[64:67], v[108:111], v[56:59], v[64:67]
    ds_read_b64_tr_b16 v[96:97], v14 offset:24
    ds_read_b64_tr_b16 v[98:99], v14 offset:2584
    v_mfma_f32_16x16x32_bf16 v[68:71], v[112:115], v[56:59], v[68:71]
    ds_read_b64_tr_b16 v[100:101], v14 offset:32
    ds_read_b64_tr_b16 v[102:103], v14 offset:2592
    v_mfma_f32_16x16x32_bf16 v[72:75], v[116:119], v[56:59], v[72:75]
    v_mfma_f32_16x16x32_bf16 v[76:79], v[120:123], v[56:59], v[76:79]
    s_waitcnt lgkmcnt(0)
    ds_read_b128 v[24:27], v17 offset:0
    ds_read_b64_tr_b16 v[104:105], v14 offset:5120
    ds_read_b64_tr_b16 v[106:107], v14 offset:7680
    ds_read_b64_tr_b16 v[108:109], v14 offset:5128
    ds_read_b64_tr_b16 v[110:111], v14 offset:7688
    v_mfma_f32_16x16x32_bf16 v[60:63], v[84:87], v[20:23], v[60:63]
    ds_read_b64_tr_b16 v[112:113], v14 offset:5136
    ds_read_b64_tr_b16 v[114:115], v14 offset:7696
    v_mfma_f32_16x16x32_bf16 v[64:67], v[88:91], v[20:23], v[64:67]
    ds_read_b64_tr_b16 v[116:117], v14 offset:5144
    ds_read_b64_tr_b16 v[118:119], v14 offset:7704
    v_mfma_f32_16x16x32_bf16 v[68:71], v[92:95], v[20:23], v[68:71]
    ds_read_b64_tr_b16 v[120:121], v14 offset:5152
    ds_read_b64_tr_b16 v[122:123], v14 offset:7712
    v_mfma_f32_16x16x32_bf16 v[72:75], v[96:99], v[20:23], v[72:75]
    v_mfma_f32_16x16x32_bf16 v[76:79], v[100:103], v[20:23], v[76:79]
    s_waitcnt lgkmcnt(0)
    ds_read_b128 v[28:31], v16 offset:128
    ds_read_b64_tr_b16 v[84:85], v14 offset:10240
    ds_read_b64_tr_b16 v[86:87], v14 offset:12800
    ds_read_b64_tr_b16 v[88:89], v14 offset:10248
    ds_read_b64_tr_b16 v[90:91], v14 offset:12808
    v_mfma_f32_16x16x32_bf16 v[60:63], v[104:107], v[24:27], v[60:63]
    ds_read_b64_tr_b16 v[92:93], v14 offset:10256
    ds_read_b64_tr_b16 v[94:95], v14 offset:12816
    v_mfma_f32_16x16x32_bf16 v[64:67], v[108:111], v[24:27], v[64:67]
    ds_read_b64_tr_b16 v[96:97], v14 offset:10264
    ds_read_b64_tr_b16 v[98:99], v14 offset:12824
    v_mfma_f32_16x16x32_bf16 v[68:71], v[112:115], v[24:27], v[68:71]
    ds_read_b64_tr_b16 v[100:101], v14 offset:10272
    ds_read_b64_tr_b16 v[102:103], v14 offset:12832
    v_mfma_f32_16x16x32_bf16 v[72:75], v[116:119], v[24:27], v[72:75]
    v_mfma_f32_16x16x32_bf16 v[76:79], v[120:123], v[24:27], v[76:79]
    s_waitcnt lgkmcnt(0)
    ds_read_b128 v[32:35], v17 offset:128
    ds_read_b64_tr_b16 v[104:105], v14 offset:15360
    ds_read_b64_tr_b16 v[106:107], v14 offset:17920
    ds_read_b64_tr_b16 v[108:109], v14 offset:15368
    ds_read_b64_tr_b16 v[110:111], v14 offset:17928
    v_mfma_f32_16x16x32_bf16 v[60:63], v[84:87], v[28:31], v[60:63]
    ds_read_b64_tr_b16 v[112:113], v14 offset:15376
    ds_read_b64_tr_b16 v[114:115], v14 offset:17936
    v_mfma_f32_16x16x32_bf16 v[64:67], v[88:91], v[28:31], v[64:67]
    ds_read_b64_tr_b16 v[116:117], v14 offset:15384
    ds_read_b64_tr_b16 v[118:119], v14 offset:17944
    v_mfma_f32_16x16x32_bf16 v[68:71], v[92:95], v[28:31], v[68:71]
    ds_read_b64_tr_b16 v[120:121], v14 offset:15392
    ds_read_b64_tr_b16 v[122:123], v14 offset:17952
    v_mfma_f32_16x16x32_bf16 v[72:75], v[96:99], v[28:31], v[72:75]
    v_mfma_f32_16x16x32_bf16 v[76:79], v[100:103], v[28:31], v[76:79]
    s_waitcnt lgkmcnt(0)
    ds_read_b128 v[36:39], v16 offset:256
    ds_read_b64_tr_b16 v[84:85], v14 offset:20480
    ds_read_b64_tr_b16 v[86:87], v14 offset:23040
    ds_read_b64_tr_b16 v[88:89], v14 offset:20488
    ds_read_b64_tr_b16 v[90:91], v14 offset:23048
    v_mfma_f32_16x16x32_bf16 v[60:63], v[104:107], v[32:35], v[60:63]
    ds_read_b64_tr_b16 v[92:93], v14 offset:20496
    ds_read_b64_tr_b16 v[94:95], v14 offset:23056
    v_mfma_f32_16x16x32_bf16 v[64:67], v[108:111], v[32:35], v[64:67]
    ds_read_b64_tr_b16 v[96:97], v14 offset:20504
    ds_read_b64_tr_b16 v[98:99], v14 offset:23064
    v_mfma_f32_16x16x32_bf16 v[68:71], v[112:115], v[32:35], v[68:71]
    ds_read_b64_tr_b16 v[100:101], v14 offset:20512
    ds_read_b64_tr_b16 v[102:103], v14 offset:23072
    v_mfma_f32_16x16x32_bf16 v[72:75], v[116:119], v[32:35], v[72:75]
    v_mfma_f32_16x16x32_bf16 v[76:79], v[120:123], v[32:35], v[76:79]
    s_waitcnt lgkmcnt(0)
    ds_read_b128 v[40:43], v17 offset:256
    ds_read_b64_tr_b16 v[104:105], v14 offset:25600
    ds_read_b64_tr_b16 v[106:107], v14 offset:28160
    ds_read_b64_tr_b16 v[108:109], v14 offset:25608
    ds_read_b64_tr_b16 v[110:111], v14 offset:28168
    v_mfma_f32_16x16x32_bf16 v[60:63], v[84:87], v[36:39], v[60:63]
    ds_read_b64_tr_b16 v[112:113], v14 offset:25616
    ds_read_b64_tr_b16 v[114:115], v14 offset:28176
    v_mfma_f32_16x16x32_bf16 v[64:67], v[88:91], v[36:39], v[64:67]
    ds_read_b64_tr_b16 v[116:117], v14 offset:25624
    ds_read_b64_tr_b16 v[118:119], v14 offset:28184
    v_mfma_f32_16x16x32_bf16 v[68:71], v[92:95], v[36:39], v[68:71]
    ds_read_b64_tr_b16 v[120:121], v14 offset:25632
    ds_read_b64_tr_b16 v[122:123], v14 offset:28192
    v_mfma_f32_16x16x32_bf16 v[72:75], v[96:99], v[36:39], v[72:75]
    v_mfma_f32_16x16x32_bf16 v[76:79], v[100:103], v[36:39], v[76:79]
    s_waitcnt lgkmcnt(0)
    ds_read_b128 v[44:47], v16 offset:384
    ds_read_b64_tr_b16 v[84:85], v14 offset:30720
    ds_read_b64_tr_b16 v[86:87], v14 offset:33280
    ds_read_b64_tr_b16 v[88:89], v14 offset:30728
    ds_read_b64_tr_b16 v[90:91], v14 offset:33288
    v_mfma_f32_16x16x32_bf16 v[60:63], v[104:107], v[40:43], v[60:63]
    ds_read_b64_tr_b16 v[92:93], v14 offset:30736
    ds_read_b64_tr_b16 v[94:95], v14 offset:33296
    v_mfma_f32_16x16x32_bf16 v[64:67], v[108:111], v[40:43], v[64:67]
    ds_read_b64_tr_b16 v[96:97], v14 offset:30744
    ds_read_b64_tr_b16 v[98:99], v14 offset:33304
    v_mfma_f32_16x16x32_bf16 v[68:71], v[112:115], v[40:43], v[68:71]
    ds_read_b64_tr_b16 v[100:101], v14 offset:30752
    ds_read_b64_tr_b16 v[102:103], v14 offset:33312
    v_mfma_f32_16x16x32_bf16 v[72:75], v[116:119], v[40:43], v[72:75]
    v_mfma_f32_16x16x32_bf16 v[76:79], v[120:123], v[40:43], v[76:79]
    s_waitcnt lgkmcnt(0)
    ds_read_b128 v[48:51], v17 offset:384
    ds_read_b64_tr_b16 v[104:105], v14 offset:35840
    ds_read_b64_tr_b16 v[106:107], v14 offset:38400
    ds_read_b64_tr_b16 v[108:109], v14 offset:35848
    ds_read_b64_tr_b16 v[110:111], v14 offset:38408
    v_mfma_f32_16x16x32_bf16 v[60:63], v[84:87], v[44:47], v[60:63]
    ds_read_b64_tr_b16 v[112:113], v14 offset:35856
    ds_read_b64_tr_b16 v[114:115], v14 offset:38416
    v_mfma_f32_16x16x32_bf16 v[64:67], v[88:91], v[44:47], v[64:67]
    ds_read_b64_tr_b16 v[116:117], v14 offset:35864
    ds_read_b64_tr_b16 v[118:119], v14 offset:38424
    v_mfma_f32_16x16x32_bf16 v[68:71], v[92:95], v[44:47], v[68:71]
    ds_read_b64_tr_b16 v[120:121], v14 offset:35872
    ds_read_b64_tr_b16 v[122:123], v14 offset:38432
    v_mfma_f32_16x16x32_bf16 v[72:75], v[96:99], v[44:47], v[72:75]
    v_mfma_f32_16x16x32_bf16 v[76:79], v[100:103], v[44:47], v[76:79]
    s_waitcnt lgkmcnt(0)
    ds_read_b128 v[52:55], v16 offset:512
    ds_read_b64_tr_b16 v[84:85], v14 offset:40960
    ds_read_b64_tr_b16 v[86:87], v14 offset:43520
    ds_read_b64_tr_b16 v[88:89], v14 offset:40968
    ds_read_b64_tr_b16 v[90:91], v14 offset:43528
    v_mfma_f32_16x16x32_bf16 v[60:63], v[104:107], v[48:51], v[60:63]
    ds_read_b64_tr_b16 v[92:93], v14 offset:40976
    ds_read_b64_tr_b16 v[94:95], v14 offset:43536
    v_mfma_f32_16x16x32_bf16 v[64:67], v[108:111], v[48:51], v[64:67]
    ds_read_b64_tr_b16 v[96:97], v14 offset:40984
    ds_read_b64_tr_b16 v[98:99], v14 offset:43544
    v_mfma_f32_16x16x32_bf16 v[68:71], v[112:115], v[48:51], v[68:71]
    ds_read_b64_tr_b16 v[100:101], v14 offset:40992
    ds_read_b64_tr_b16 v[102:103], v14 offset:43552
    v_mfma_f32_16x16x32_bf16 v[72:75], v[116:119], v[48:51], v[72:75]
    v_mfma_f32_16x16x32_bf16 v[76:79], v[120:123], v[48:51], v[76:79]
    s_waitcnt lgkmcnt(0)
    ds_read_b128 v[56:59], v17 offset:512
    ds_read_b64_tr_b16 v[104:105], v14 offset:46080
    ds_read_b64_tr_b16 v[106:107], v14 offset:48640
    ds_read_b64_tr_b16 v[108:109], v14 offset:46088
    ds_read_b64_tr_b16 v[110:111], v14 offset:48648
    v_mfma_f32_16x16x32_bf16 v[60:63], v[84:87], v[52:55], v[60:63]
    ds_read_b64_tr_b16 v[112:113], v14 offset:46096
    ds_read_b64_tr_b16 v[114:115], v14 offset:48656
    v_mfma_f32_16x16x32_bf16 v[64:67], v[88:91], v[52:55], v[64:67]
    ds_read_b64_tr_b16 v[116:117], v14 offset:46104
    ds_read_b64_tr_b16 v[118:119], v14 offset:48664
    v_mfma_f32_16x16x32_bf16 v[68:71], v[92:95], v[52:55], v[68:71]
    ds_read_b64_tr_b16 v[120:121], v14 offset:46112
    ds_read_b64_tr_b16 v[122:123], v14 offset:48672
    v_mfma_f32_16x16x32_bf16 v[72:75], v[96:99], v[52:55], v[72:75]
    v_mfma_f32_16x16x32_bf16 v[76:79], v[100:103], v[52:55], v[76:79]
    s_waitcnt lgkmcnt(0)
    v_mfma_f32_16x16x32_bf16 v[60:63], v[104:107], v[56:59], v[60:63]
    v_mfma_f32_16x16x32_bf16 v[64:67], v[108:111], v[56:59], v[64:67]
    v_mfma_f32_16x16x32_bf16 v[68:71], v[112:115], v[56:59], v[68:71]
    v_mfma_f32_16x16x32_bf16 v[72:75], v[116:119], v[56:59], v[72:75]
    v_mfma_f32_16x16x32_bf16 v[76:79], v[120:123], v[56:59], v[76:79]
    s_nop 4
    v_cvt_pk_bf16_f32 v20, v60, v61
    v_cvt_pk_bf16_f32 v21, v62, v63
    v_cvt_pk_bf16_f32 v22, v64, v65
    v_cvt_pk_bf16_f32 v23, v66, v67
    v_cvt_pk_bf16_f32 v24, v68, v69
    v_cvt_pk_bf16_f32 v25, v70, v71
    v_cvt_pk_bf16_f32 v26, v72, v73
    v_cvt_pk_bf16_f32 v27, v74, v75
    v_cvt_pk_bf16_f32 v28, v76, v77
    v_cvt_pk_bf16_f32 v29, v78, v79
    ds_write_b128 v6, v[20:23] offset:0
    ds_write_b128 v6, v[24:27] offset:512
    ds_write_b64 v7, v[28:29] offset:1024
    s_waitcnt lgkmcnt(0)
    s_barrier
K2_ATT:
    s_lshr_b32 s4, s3, 2
    s_lshr_b32 s6, s2, 3
    s_add_u32 s7, s6, s3
    s_and_b32 s7, s7, 7
    s_lshr_b32 s52, s6, 3
    s_and_b32 s52, s52, 1
    s_lshl_b32 s9, s7, 1
    s_add_u32 s10, s9, s52
    s_xor_b32 s11, s10, 1
    s_lshl_b32 s12, s10, 12
    s_add_u32 s12, s12, 2621440
    s_lshl_b32 s13, s11, 12
    s_add_u32 s13, s13, 2621440
    s_lshl_b32 s14, s10, 10
    s_add_u32 s14, s14, 2686976
    s_lshl_b32 s15, s11, 10
    s_add_u32 s15, s15, 2686976
    s_mul_i32 s42, s10, 5120
    s_add_u32 s42, s42, 2703360
    s_mul_i32 s43, s11, 5120
    s_add_u32 s43, s43, 2703360
    s_add_u32 s48, s42, 2560
    s_add_u32 s49, s43, 2560
    v_lshlrev_b32 v2, 4, v0
    v_and_b32 v6, 31, v0
    v_lshrrev_b32 v7, 5, v0
    v_mad_u32_u24 v5, v7, 20, v6
    v_lshlrev_b32 v5, 4, v5
    v_lshlrev_b32 v3, 3, v6
    v_lshl_add_u32 v3, v7, 2, v3
    v_cmp_gt_u32 s[50:51], 20, v6
    v_cmp_eq_u32 vcc, 20, v6
    v_mov_b32 v7, 0x3f803f80
    s_mul_i32 s5, s3, 3072
    v_cndmask_b32 v6, 0, v7, vcc
    v_cndmask_b32 v7, 0, v7, vcc
    s_add_u32 s5, s5, 10496
    v_add_u32 v4, s5, v2
    v_cmp_gt_u32 vcc, 4, v0
    v_lshlrev_b32 v0, 2, v0
    v_add_u32 v0, 10272, v0
    s_xor_b32 s5, s3, 4
    s_lshl_b32 s5, s5, 2
    s_add_u32 s5, s5, 10240
    v_mov_b32 v1, s5
    v_cndmask_b32 v0, v1, v0, vcc
    s_waitcnt lgkmcnt(0)
    s_mov_b32 s44, s40
    s_and_b32 s45, s41, 0xffff
    s_mov_b32 s46, 11513856
    s_mov_b32 s47, 0x20000
    s_setprio 3
    s_cmp_eq_u32 s4, 0
    s_cbranch_scc1 K2_A_LATE
    buffer_load_dwordx4 v[96:99], v2, s[44:47], s14 offen sc1
    buffer_load_dwordx4 v[100:103], v2, s[44:47], s15 offen sc1
    buffer_load_dwordx4 v[64:67], v2, s[44:47], s12 offen offset:0 sc1
    buffer_load_dwordx4 v[68:71], v2, s[44:47], s12 offen offset:1024 sc1
    s_mov_b64 exec, s[50:51]
    buffer_load_dwordx4 v[104:107], v5, s[44:47], s42 offen offset:0 sc1
    buffer_load_dwordx4 v[108:111], v5, s[44:47], s42 offen offset:640 sc1
    s_mov_b64 exec, -1
    buffer_load_dwordx4 v[72:75], v2, s[44:47], s12 offen offset:2048 sc1
    s_mov_b64 exec, s[50:51]
    buffer_load_dwordx4 v[112:115], v5, s[44:47], s42 offen offset:1280 sc1
    buffer_load_dwordx4 v[116:119], v5, s[44:47], s42 offen offset:1920 sc1
    s_mov_b64 exec, -1
    s_andn2_b64 exec, -1, s[50:51]
    v_mov_b64 v[104:105], v[6:7]
    v_mov_b64 v[106:107], v[6:7]
    v_mov_b64 v[108:109], v[6:7]
    v_mov_b64 v[110:111], v[6:7]
    v_mov_b64 v[112:113], v[6:7]
    v_mov_b64 v[114:115], v[6:7]
    v_mov_b64 v[116:117], v[6:7]
    v_mov_b64 v[118:119], v[6:7]
    v_mov_b64 v[120:121], v[6:7]
    v_mov_b64 v[122:123], v[6:7]
    v_mov_b64 v[124:125], v[6:7]
    v_mov_b64 v[126:127], v[6:7]
    v_mov_b64 v[128:129], v[6:7]
    v_mov_b64 v[130:131], v[6:7]
    v_mov_b64 v[132:133], v[6:7]
    v_mov_b64 v[134:135], v[6:7]
    v_mov_b64 v[136:137], v[6:7]
    v_mov_b64 v[138:139], v[6:7]
    v_mov_b64 v[140:141], v[6:7]
    v_mov_b64 v[142:143], v[6:7]
    v_mov_b64 v[144:145], v[6:7]
    v_mov_b64 v[146:147], v[6:7]
    v_mov_b64 v[148:149], v[6:7]
    v_mov_b64 v[150:151], v[6:7]
    v_mov_b64 v[152:153], v[6:7]
    v_mov_b64 v[154:155], v[6:7]
    v_mov_b64 v[156:157], v[6:7]
    v_mov_b64 v[158:159], v[6:7]
    v_mov_b64 v[160:161], v[6:7]
    v_mov_b64 v[162:163], v[6:7]
    v_mov_b64 v[164:165], v[6:7]
    v_mov_b64 v[166:167], v[6:7]
    s_mov_b64 exec, -1
    v_mov_b32 v1, 0xdddddddd
    v_mov_b32 v61, 0
    v_mov_b32 v62, 0
    buffer_load_dwordx4 v[76:79], v2, s[44:47], s12 offen offset:3072 sc1
    s_mov_b64 exec, s[50:51]
    buffer_load_dwordx4 v[120:123], v5, s[44:47], s48 offen offset:0 sc1
    buffer_load_dwordx4 v[124:127], v5, s[44:47], s48 offen offset:640 sc1
    s_mov_b64 exec, -1
    buffer_load_dwordx4 v[80:83], v2, s[44:47], s13 offen offset:0 sc1
    s_mov_b64 exec, s[50:51]
    buffer_load_dwordx4 v[128:131], v5, s[44:47], s48 offen offset:1280 sc1
    buffer_load_dwordx4 v[132:135], v5, s[44:47], s48 offen offset:1920 sc1
    s_mov_b64 exec, -1
    buffer_load_dwordx4 v[84:87], v2, s[44:47], s13 offen offset:1024 sc1
    s_mov_b64 exec, s[50:51]
    buffer_load_dwordx4 v[136:139], v5, s[44:47], s43 offen offset:0 sc1
    buffer_load_dwordx4 v[140:143], v5, s[44:47], s43 offen offset:640 sc1
    s_mov_b64 exec, -1
    buffer_load_dwordx4 v[88:91], v2, s[44:47], s13 offen offset:2048 sc1
    s_mov_b64 exec, s[50:51]
    buffer_load_dwordx4 v[144:147], v5, s[44:47], s43 offen offset:1280 sc1
    buffer_load_dwordx4 v[148:151], v5, s[44:47], s43 offen offset:1920 sc1
    s_mov_b64 exec, -1
    buffer_load_dwordx4 v[92:95], v2, s[44:47], s13 offen offset:3072 sc1
    s_mov_b64 exec, s[50:51]
    buffer_load_dwordx4 v[152:155], v5, s[44:47], s49 offen offset:0 sc1
    buffer_load_dwordx4 v[156:159], v5, s[44:47], s49 offen offset:640 sc1
    s_mov_b64 exec, -1
    s_mov_b64 exec, s[50:51]
    buffer_load_dwordx4 v[160:163], v5, s[44:47], s49 offen offset:1280 sc1
    buffer_load_dwordx4 v[164:167], v5, s[44:47], s49 offen offset:1920 sc1
    s_mov_b64 exec, -1
    s_waitcnt lgkmcnt(0)
    s_barrier
    s_setprio 1
    ds_read_b128 v[56:59], v2 offset:0
    ds_read_b32 v60, v3 offset:1024
    ds_read_b32 v63, v3 offset:1024
    v_add_u32 v2, 1280, v2
    v_add_u32 v3, 2304, v3
    s_lshl_b32 s8, s3, 2
    s_add_u32 s8, s8, 10240
    v_mov_b32 v5, s8
    v_mov_b32 v7, 1
    ds_write_b32 v5, v7 offset:224
    s_mov_b32 s9, 49152
    s_mov_b32 s11, 0
    s_mov_b64 vcc, 0
    s_waitcnt vmcnt(23) lgkmcnt(0)
    v_mfma_f32_32x32x16_bf16 v[8:23], v[64:67], v[56:59], 0
    v_mfma_f32_32x32x8_bf16 v[8:23], v[96:97], v[60:61], v[8:23]
    s_waitcnt vmcnt(20)
    s_nop 12
    s_branch K2_A_LOOP
K2_A_LATE:
    buffer_load_dwordx4 v[96:99], v2, s[44:47], s14 offen sc1
    buffer_load_dwordx4 v[100:103], v2, s[44:47], s15 offen sc1
    buffer_load_dwordx4 v[64:67], v2, s[44:47], s12 offen offset:0 sc1
    buffer_load_dwordx4 v[68:71], v2, s[44:47], s12 offen offset:1024 sc1
    s_mov_b64 exec, s[50:51]
    buffer_load_dwordx4 v[104:107], v5, s[44:47], s42 offen offset:0 sc1
    buffer_load_dwordx4 v[108:111], v5, s[44:47], s42 offen offset:640 sc1
    s_mov_b64 exec, -1
    buffer_load_dwordx4 v[72:75], v2, s[44:47], s12 offen offset:2048 sc1
    s_mov_b64 exec, s[50:51]
    buffer_load_dwordx4 v[112:115], v5, s[44:47], s42 offen offset:1280 sc1
    buffer_load_dwordx4 v[116:119], v5, s[44:47], s42 offen offset:1920 sc1
    s_mov_b64 exec, -1
    buffer_load_dwordx4 v[76:79], v2, s[44:47], s12 offen offset:3072 sc1
    s_mov_b64 exec, s[50:51]
    buffer_load_dwordx4 v[120:123], v5, s[44:47], s48 offen offset:0 sc1
    buffer_load_dwordx4 v[124:127], v5, s[44:47], s48 offen offset:640 sc1
    s_mov_b64 exec, -1
    buffer_load_dwordx4 v[80:83], v2, s[44:47], s13 offen offset:0 sc1
    s_mov_b64 exec, s[50:51]
    buffer_load_dwordx4 v[128:131], v5, s[44:47], s48 offen offset:1280 sc1
    buffer_load_dwordx4 v[132:135], v5, s[44:47], s48 offen offset:1920 sc1
    s_mov_b64 exec, -1
    s_andn2_b64 exec, -1, s[50:51]
    v_mov_b64 v[104:105], v[6:7]
    v_mov_b64 v[106:107], v[6:7]
    v_mov_b64 v[108:109], v[6:7]
    v_mov_b64 v[110:111], v[6:7]
    v_mov_b64 v[112:113], v[6:7]
    v_mov_b64 v[114:115], v[6:7]
    v_mov_b64 v[116:117], v[6:7]
    v_mov_b64 v[118:119], v[6:7]
    v_mov_b64 v[120:121], v[6:7]
    v_mov_b64 v[122:123], v[6:7]
    v_mov_b64 v[124:125], v[6:7]
    v_mov_b64 v[126:127], v[6:7]
    v_mov_b64 v[128:129], v[6:7]
    v_mov_b64 v[130:131], v[6:7]
    v_mov_b64 v[132:133], v[6:7]
    v_mov_b64 v[134:135], v[6:7]
    v_mov_b64 v[136:137], v[6:7]
    v_mov_b64 v[138:139], v[6:7]
    v_mov_b64 v[140:141], v[6:7]
    v_mov_b64 v[142:143], v[6:7]
    v_mov_b64 v[144:145], v[6:7]
    v_mov_b64 v[146:147], v[6:7]
    v_mov_b64 v[148:149], v[6:7]
    v_mov_b64 v[150:151], v[6:7]
    v_mov_b64 v[152:153], v[6:7]
    v_mov_b64 v[154:155], v[6:7]
    v_mov_b64 v[156:157], v[6:7]
    v_mov_b64 v[158:159], v[6:7]
    v_mov_b64 v[160:161], v[6:7]
    v_mov_b64 v[162:163], v[6:7]
    v_mov_b64 v[164:165], v[6:7]
    v_mov_b64 v[166:167], v[6:7]
    s_mov_b64 exec, -1
    v_mov_b32 v1, 0xdddddddd
    v_mov_b32 v61, 0
    v_mov_b32 v62, 0
    v_mov_b64 v[40:41], 0
    v_mov_b64 v[42:43], 0
    v_mov_b64 v[44:45], 0
    v_mov_b64 v[46:47], 0
    v_mov_b64 v[48:49], 0
    v_mov_b64 v[50:51], 0
    s_cmp_eq_u32 s4, 0
    s_cbranch_scc1 K2_A_NOBX
    s_waitcnt lgkmcnt(0)
    s_barrier
    s_branch K2_A_GO
K2_A_NOBX:
    s_setprio 0
K2_A_GO:
    ds_read_b128 v[56:59], v2 offset:0
    ds_read_b32 v60, v3 offset:1024
    ds_read_b32 v63, v3 offset:1024
    s_waitcnt vmcnt(12) lgkmcnt(0)
    v_mfma_f32_32x32x16_bf16 v[8:23], v[64:67], v[56:59], 0
    v_mfma_f32_32x32x8_bf16 v[8:23], v[96:97], v[60:61], v[8:23]
    buffer_load_dwordx4 v[84:87], v2, s[44:47], s13 offen offset:1024 sc1
    s_mov_b64 exec, s[50:51]
    buffer_load_dwordx4 v[136:139], v5, s[44:47], s43 offen offset:0 sc1
    buffer_load_dwordx4 v[140:143], v5, s[44:47], s43 offen offset:640 sc1
    s_mov_b64 exec, -1
    s_waitcnt vmcnt(12)
    s_nop 5
    v_exp_f32 v8, v8
    v_exp_f32 v9, v9
    v_exp_f32 v10, v10
    v_exp_f32 v11, v11
    v_mfma_f32_32x32x16_bf16 v[24:39], v[68:71], v[56:59], 0
    v_exp_f32 v12, v12
    v_exp_f32 v13, v13
    v_exp_f32 v14, v14
    v_exp_f32 v15, v15
    v_mfma_f32_32x32x8_bf16 v[24:39], v[96:97], v[62:63], v[24:39]
    buffer_load_dwordx4 v[88:91], v2, s[44:47], s13 offen offset:2048 sc1
    s_mov_b64 exec, s[50:51]
    buffer_load_dwordx4 v[144:147], v5, s[44:47], s43 offen offset:1280 sc1
    buffer_load_dwordx4 v[148:151], v5, s[44:47], s43 offen offset:1920 sc1
    s_mov_b64 exec, -1
    v_exp_f32 v16, v16
    v_exp_f32 v17, v17
    v_exp_f32 v18, v18
    v_exp_f32 v19, v19
    v_smfmac_f32_32x32x32_bf16 v[40:55], v[104:107], v[8:15], v1
    buffer_load_dwordx4 v[92:95], v2, s[44:47], s13 offen offset:3072 sc1
    s_mov_b64 exec, s[50:51]
    buffer_load_dwordx4 v[152:155], v5, s[44:47], s49 offen offset:0 sc1
    buffer_load_dwordx4 v[156:159], v5, s[44:47], s49 offen offset:640 sc1
    s_mov_b64 exec, -1
    v_exp_f32 v20, v20
    v_exp_f32 v21, v21
    v_exp_f32 v22, v22
    v_exp_f32 v23, v23
    s_waitcnt vmcnt(15)
    s_nop 0
    v_smfmac_f32_32x32x32_bf16 v[40:55], v[108:111], v[16:23], v1
    v_exp_f32 v24, v24
    v_exp_f32 v25, v25
    v_exp_f32 v26, v26
    v_exp_f32 v27, v27
    v_mfma_f32_32x32x16_bf16 v[8:23], v[72:75], v[56:59], 0
    v_exp_f32 v28, v28
    v_exp_f32 v29, v29
    v_exp_f32 v30, v30
    v_exp_f32 v31, v31
    v_mfma_f32_32x32x8_bf16 v[8:23], v[98:99], v[60:61], v[8:23]
    s_mov_b64 exec, s[50:51]
    buffer_load_dwordx4 v[160:163], v5, s[44:47], s49 offen offset:1280 sc1
    buffer_load_dwordx4 v[164:167], v5, s[44:47], s49 offen offset:1920 sc1
    s_mov_b64 exec, -1
    v_exp_f32 v32, v32
    v_exp_f32 v33, v33
    v_exp_f32 v34, v34
    v_exp_f32 v35, v35
    v_smfmac_f32_32x32x32_bf16 v[40:55], v[112:115], v[24:31], v1
    v_exp_f32 v36, v36
    v_exp_f32 v37, v37
    v_exp_f32 v38, v38
    v_exp_f32 v39, v39
    s_waitcnt vmcnt(14)
    s_nop 0
    v_smfmac_f32_32x32x32_bf16 v[40:55], v[116:119], v[32:39], v1
    v_add_u32 v2, 1280, v2
    v_add_u32 v3, 2304, v3
    s_lshl_b32 s8, s3, 2
    s_add_u32 s8, s8, 10240
    v_mov_b32 v5, s8
    v_mov_b32 v7, 1
    ds_write_b32 v5, v7 offset:224
    s_mov_b32 s9, 0
    s_mov_b32 s11, 0
    s_mov_b64 vcc, 0
    s_setprio 1
    s_cmp_eq_u32 s4, 0
    s_cbranch_scc0 K2_A_TILE2
    s_setprio 1
    s_branch K2_A_TILE2
.p2align 6
K2_A_LOOP:
    v_exp_f32 v8, v8
    v_exp_f32 v9, v9
    v_exp_f32 v10, v10
    v_exp_f32 v11, v11
    v_mfma_f32_32x32x16_bf16 v[24:39], v[68:71], v[56:59], 0
    v_exp_f32 v12, v12
    v_exp_f32 v13, v13
    v_exp_f32 v14, v14
    v_exp_f32 v15, v15
    v_mfma_f32_32x32x8_bf16 v[24:39], v[96:97], v[62:63], v[24:39]
    v_add_u32 v6, s9, v4
    v_exp_f32 v16, v16
    v_exp_f32 v17, v17
    v_exp_f32 v18, v18
    v_exp_f32 v19, v19
    v_mov_b32 v7, s11
    ds_write_b128 v6, v[40:43] offset:0
    ds_write_b128 v6, v[44:47] offset:1024
    ds_write_b128 v6, v[48:51] offset:2048
    ds_write_b32 v5, v7 offset:0
    ds_read_b32 v7, v0
    v_mov_b64 v[40:41], 0
    v_mov_b64 v[42:43], 0
    v_mov_b64 v[44:45], 0
    v_mov_b64 v[46:47], 0
    v_mov_b64 v[48:49], 0
    v_mov_b64 v[50:51], 0
    v_exp_f32 v20, v20
    v_exp_f32 v21, v21
    v_smfmac_f32_32x32x32_bf16 v[40:55], v[104:107], v[8:15], v1
    v_exp_f32 v22, v22
    v_exp_f32 v23, v23
    s_add_u32 s9, s9, 24576
    s_cmp_eq_u32 s9, 73728
    s_cselect_b32 s9, 0, s9
    s_waitcnt vmcnt(17)
    v_smfmac_f32_32x32x32_bf16 v[40:55], v[108:111], v[16:23], v1
    v_exp_f32 v24, v24
    v_exp_f32 v25, v25
    v_exp_f32 v26, v26
    v_exp_f32 v27, v27
    v_mfma_f32_32x32x16_bf16 v[8:23], v[72:75], v[56:59], 0
    v_exp_f32 v28, v28
    v_exp_f32 v29, v29
    v_exp_f32 v30, v30
    v_exp_f32 v31, v31
    v_mfma_f32_32x32x8_bf16 v[8:23], v[98:99], v[60:61], v[8:23]
    s_waitcnt lgkmcnt(0)
    v_cmp_gt_i32 s[54:55], s11, v7
    v_exp_f32 v32, v32
    v_exp_f32 v33, v33
    v_exp_f32 v34, v34
    v_exp_f32 v35, v35
    v_smfmac_f32_32x32x32_bf16 v[40:55], v[112:115], v[24:31], v1
    v_exp_f32 v36, v36
    v_exp_f32 v37, v37
    v_exp_f32 v38, v38
    v_exp_f32 v39, v39
    s_or_b64 vcc, vcc, s[54:55]
    s_waitcnt vmcnt(14)
    s_cbranch_vccnz K2_A_CK1
K2_A_RT1:
    v_smfmac_f32_32x32x32_bf16 v[40:55], v[116:119], v[32:39], v1
K2_A_TILE2:
    v_exp_f32 v8, v8
    v_exp_f32 v9, v9
    v_exp_f32 v10, v10
    v_exp_f32 v11, v11
    v_mfma_f32_32x32x16_bf16 v[24:39], v[76:79], v[56:59], 0
    v_exp_f32 v12, v12
    v_exp_f32 v13, v13
    v_exp_f32 v14, v14
    v_exp_f32 v15, v15
    v_mfma_f32_32x32x8_bf16 v[24:39], v[98:99], v[62:63], v[24:39]
    v_exp_f32 v16, v16
    v_exp_f32 v17, v17
    v_exp_f32 v18, v18
    v_exp_f32 v19, v19
    v_smfmac_f32_32x32x32_bf16 v[40:55], v[120:123], v[8:15], v1
    v_exp_f32 v20, v20
    v_exp_f32 v21, v21
    v_exp_f32 v22, v22
    v_exp_f32 v23, v23
    s_waitcnt vmcnt(11)
    s_cbranch_vccnz K2_A_CK2
K2_A_RT2:
    v_smfmac_f32_32x32x32_bf16 v[40:55], v[124:127], v[16:23], v1
    v_exp_f32 v24, v24
    v_exp_f32 v25, v25
    v_exp_f32 v26, v26
    v_exp_f32 v27, v27
    v_mfma_f32_32x32x16_bf16 v[8:23], v[80:83], v[56:59], 0
    v_exp_f32 v28, v28
    v_exp_f32 v29, v29
    v_exp_f32 v30, v30
    v_exp_f32 v31, v31
    v_mfma_f32_32x32x8_bf16 v[8:23], v[100:101], v[60:61], v[8:23]
    v_exp_f32 v32, v32
    v_exp_f32 v33, v33
    v_exp_f32 v34, v34
    v_exp_f32 v35, v35
    v_smfmac_f32_32x32x32_bf16 v[40:55], v[128:131], v[24:31], v1
    v_exp_f32 v36, v36
    v_exp_f32 v37, v37
    v_exp_f32 v38, v38
    v_exp_f32 v39, v39
    s_waitcnt vmcnt(8)
    s_cbranch_vccnz K2_A_CK3
K2_A_RT3:
    v_smfmac_f32_32x32x32_bf16 v[40:55], v[132:135], v[32:39], v1
    v_exp_f32 v8, v8
    v_exp_f32 v9, v9
    v_exp_f32 v10, v10
    v_exp_f32 v11, v11
    v_mfma_f32_32x32x16_bf16 v[24:39], v[84:87], v[56:59], 0
    v_exp_f32 v12, v12
    v_exp_f32 v13, v13
    v_exp_f32 v14, v14
    v_exp_f32 v15, v15
    v_mfma_f32_32x32x8_bf16 v[24:39], v[100:101], v[62:63], v[24:39]
    v_exp_f32 v16, v16
    v_exp_f32 v17, v17
    v_exp_f32 v18, v18
    v_exp_f32 v19, v19
    v_smfmac_f32_32x32x32_bf16 v[40:55], v[136:139], v[8:15], v1
    v_exp_f32 v20, v20
    v_exp_f32 v21, v21
    v_exp_f32 v22, v22
    v_exp_f32 v23, v23
    s_waitcnt vmcnt(5)
    s_cbranch_vccnz K2_A_CK4
K2_A_RT4:
    v_smfmac_f32_32x32x32_bf16 v[40:55], v[140:143], v[16:23], v1
    v_exp_f32 v24, v24
    v_exp_f32 v25, v25
    v_exp_f32 v26, v26
    v_exp_f32 v27, v27
    v_mfma_f32_32x32x16_bf16 v[8:23], v[88:91], v[56:59], 0
    v_exp_f32 v28, v28
    v_exp_f32 v29, v29
    v_exp_f32 v30, v30
    v_exp_f32 v31, v31
    v_mfma_f32_32x32x8_bf16 v[8:23], v[102:103], v[60:61], v[8:23]
    v_exp_f32 v32, v32
    v_exp_f32 v33, v33
    v_exp_f32 v34, v34
    v_exp_f32 v35, v35
    v_smfmac_f32_32x32x32_bf16 v[40:55], v[144:147], v[24:31], v1
    v_exp_f32 v36, v36
    v_exp_f32 v37, v37
    v_exp_f32 v38, v38
    v_exp_f32 v39, v39
    s_waitcnt vmcnt(2)
    s_cbranch_vccnz K2_A_CK5
K2_A_RT5:
    v_smfmac_f32_32x32x32_bf16 v[40:55], v[148:151], v[32:39], v1
    v_exp_f32 v8, v8
    v_exp_f32 v9, v9
    v_exp_f32 v10, v10
    v_exp_f32 v11, v11
    v_mfma_f32_32x32x16_bf16 v[24:39], v[92:95], v[56:59], 0
    v_exp_f32 v12, v12
    v_exp_f32 v13, v13
    v_exp_f32 v14, v14
    v_exp_f32 v15, v15
    v_mfma_f32_32x32x8_bf16 v[24:39], v[102:103], v[62:63], v[24:39]
    ds_read_b128 v[56:59], v2
    ds_read_b32 v60, v3
    ds_read_b32 v63, v3
    v_add_u32 v2, 1280, v2
    v_add_u32 v3, 1280, v3
    v_exp_f32 v16, v16
    v_exp_f32 v17, v17
    v_exp_f32 v18, v18
    v_exp_f32 v19, v19
    v_smfmac_f32_32x32x32_bf16 v[40:55], v[152:155], v[8:15], v1
    v_exp_f32 v20, v20
    v_exp_f32 v21, v21
    v_exp_f32 v22, v22
    v_exp_f32 v23, v23
    s_waitcnt vmcnt(0)
    s_cbranch_vccnz K2_A_CK6
K2_A_RT6:
    v_smfmac_f32_32x32x32_bf16 v[40:55], v[156:159], v[16:23], v1
    v_exp_f32 v24, v24
    v_exp_f32 v25, v25
    v_exp_f32 v26, v26
    v_exp_f32 v27, v27
    s_waitcnt lgkmcnt(0)
    v_mfma_f32_32x32x16_bf16 v[8:23], v[64:67], v[56:59], 0
    v_exp_f32 v28, v28
    v_exp_f32 v29, v29
    v_exp_f32 v30, v30
    v_exp_f32 v31, v31
    v_mfma_f32_32x32x8_bf16 v[8:23], v[96:97], v[60:61], v[8:23]
    v_exp_f32 v32, v32
    v_exp_f32 v33, v33
    v_exp_f32 v34, v34
    v_exp_f32 v35, v35
    v_smfmac_f32_32x32x32_bf16 v[40:55], v[160:163], v[24:31], v1
    v_exp_f32 v36, v36
    v_exp_f32 v37, v37
    v_exp_f32 v38, v38
    v_exp_f32 v39, v39
    s_add_u32 s11, s11, 1
    s_cmp_lt_u32 s11, 8
    v_smfmac_f32_32x32x32_bf16 v[40:55], v[164:167], v[32:39], v1
    s_cbranch_scc1 K2_A_LOOP
    v_add_u32 v6, s9, v4
    s_nop 9
    v_mov_b32 v7, 8
    ds_write_b128 v6, v[40:43] offset:0
    ds_write_b128 v6, v[44:47] offset:1024
    ds_write_b128 v6, v[48:51] offset:2048
    ds_write_b32 v5, v7 offset:0
    s_waitcnt lgkmcnt(0)
    s_branch P3_ATT
K2_A_CK1:
    s_waitcnt lgkmcnt(0)
    v_cmp_gt_i32 vcc, s11, v7
    ds_read_b32 v7, v0
    s_setprio 0
    s_nop 1
    s_and_b32 s10, vcc_lo, 15
    s_cbranch_scc1 K2_A_CS1
    s_cbranch_vccnz K2_A_RT1
    s_setprio 1
    s_cmp_eq_u32 s4, 1
    s_cbranch_scc1 K2_A_RT1
    s_setprio 1
    s_branch K2_A_RT1
K2_A_CS1:
    s_sleep 1
    s_branch K2_A_CK1
K2_A_CK2:
    s_waitcnt lgkmcnt(0)
    v_cmp_gt_i32 vcc, s11, v7
    ds_read_b32 v7, v0
    s_setprio 0
    s_nop 1
    s_and_b32 s10, vcc_lo, 15
    s_cbranch_scc1 K2_A_CS2
    s_cbranch_vccnz K2_A_RT2
    s_setprio 1
    s_cmp_eq_u32 s4, 1
    s_cbranch_scc1 K2_A_RT2
    s_setprio 1
    s_branch K2_A_RT2
K2_A_CS2:
    s_sleep 1
    s_branch K2_A_CK2
K2_A_CK3:
    s_waitcnt lgkmcnt(0)
    v_cmp_gt_i32 vcc, s11, v7
    ds_read_b32 v7, v0
    s_setprio 0
    s_nop 1
    s_and_b32 s10, vcc_lo, 15
    s_cbranch_scc1 K2_A_CS3
    s_cbranch_vccnz K2_A_RT3
    s_setprio 1
    s_cmp_eq_u32 s4, 1
    s_cbranch_scc1 K2_A_RT3
    s_setprio 1
    s_branch K2_A_RT3
K2_A_CS3:
    s_sleep 1
    s_branch K2_A_CK3
K2_A_CK4:
    s_waitcnt lgkmcnt(0)
    v_cmp_gt_i32 vcc, s11, v7
    ds_read_b32 v7, v0
    s_setprio 0
    s_nop 1
    s_and_b32 s10, vcc_lo, 15
    s_cbranch_scc1 K2_A_CS4
    s_cbranch_vccnz K2_A_RT4
    s_setprio 1
    s_cmp_eq_u32 s4, 1
    s_cbranch_scc1 K2_A_RT4
    s_setprio 1
    s_branch K2_A_RT4
K2_A_CS4:
    s_sleep 1
    s_branch K2_A_CK4
K2_A_CK5:
    s_waitcnt lgkmcnt(0)
    v_cmp_gt_i32 vcc, s11, v7
    ds_read_b32 v7, v0
    s_setprio 0
    s_nop 1
    s_and_b32 s10, vcc_lo, 15
    s_cbranch_scc1 K2_A_CS5
    s_cbranch_vccnz K2_A_RT5
    s_setprio 1
    s_cmp_eq_u32 s4, 1
    s_cbranch_scc1 K2_A_RT5
    s_setprio 1
    s_branch K2_A_RT5
K2_A_CS5:
    s_sleep 1
    s_branch K2_A_CK5
K2_A_CK6:
    s_waitcnt lgkmcnt(0)
    v_cmp_gt_i32 vcc, s11, v7
    ds_read_b32 v7, v0
    s_setprio 0
    s_nop 1
    s_and_b32 s10, vcc_lo, 15
    s_cbranch_scc1 K2_A_CS6
    s_cbranch_vccnz K2_A_RT6
    s_setprio 1
    s_cmp_eq_u32 s4, 1
    s_cbranch_scc1 K2_A_RT6
    s_setprio 1
    s_branch K2_A_RT6
K2_A_CS6:
    s_sleep 1
    s_branch K2_A_CK6
K2_HELPER:
    s_setprio 3
    s_sub_u32 s4, s3, 8
    v_lshlrev_b32 v4, 4, v0
    s_mov_b32 s87, s59
K2_H_NOQ:
    s_and_b32 s5, s2, 7
    s_lshr_b32 s6, s2, 3
    s_and_b32 s7, s6, 1
    s_lshr_b32 s13, s6, 1
    s_mul_i32 s13, s13, 5
    s_mul_i32 s14, s7, 3
    s_add_u32 s8, s13, s14
    s_add_u32 s9, s8, 1
    s_add_u32 s10, s13, 2
    s_cmp_eq_u32 s4, 1
    s_cselect_b32 s11, s9, s8
    s_cmp_eq_u32 s4, 2
    s_cselect_b32 s11, s10, s11
    s_mul_i32 s14, s5, 80
    s_add_u32 s11, s11, s14
    s_lshl_b32 s12, s11, 12
    s_mul_i32 s13, s4, 19712
    s_add_u32 s13, s13, 84224
    s_add_u32 s14, s12, 2785280
    s_add_u32 s48, s40, s14
    s_addc_u32 s49, s41, 0
    s_and_b32 s49, s49, 0xffff
    s_mov_b32 s50, 4096
    s_mov_b32 s51, 0x20000
    s_add_u32 s52, s24, s12
    s_addc_u32 s53, s25, 0
    s_and_b32 s53, s53, 0xffff
    s_mov_b32 s54, 4096
    s_mov_b32 s55, 0x20000
    v_mul_u32_u24 v160, 7282, v0
    v_lshrrev_b32 v160, 16, v160
    v_lshlrev_b32 v160, 4, v160
    v_sub_u32 v161, v4, v160
    v_add_u32 v56, -1922, v161
    v_add_u32 v57, -1920, v161
    v_add_u32 v58, -1026, v161
    v_add_u32 v59, -1024, v161
    v_add_u32 v60, -130, v161
    v_add_u32 v61, -128, v161
    v_add_u32 v62, 766, v161
    v_add_u32 v63, 768, v161
    v_add_u32 v64, 1662, v161
    v_add_u32 v65, 1664, v161
    v_add_u32 v66, 2558, v161
    v_add_u32 v67, 2560, v161
    v_add_u32 v68, 3454, v161
    v_add_u32 v69, 3456, v161
    v_add_u32 v70, 4096, v4
    v_cmp_eq_u32 vcc, 7, v0
    v_lshlrev_b32 v160, 1, v0
    s_lshl_b32 s14, s11, 1
    v_cndmask_b32 v51, v160, 0, vcc
    v_mov_b32 v71, s14
    v_add_u32 v160, 2162, v160
    v_mov_b32 v161, 9456
    v_cndmask_b32 v160, v160, v161, vcc
    s_add_u32 s14, s13, 5120
    v_add_u32 v50, s14, v160
    s_mov_b32 s80, s18
    s_and_b32 s81, s19, 0xffff
    s_mov_b32 s82, 2621440
    s_mov_b32 s83, 0x20000
    s_mov_b32 s98, s20
    s_and_b32 s99, s21, 0xffff
    s_mov_b32 s90, s22
    s_mov_b32 s91, s23
    v_lshrrev_b32 v160, 3, v0
    v_and_b32 v161, 7, v0
    s_lshl_b32 s14, s6, 6
    v_lshl_add_u32 v162, v160, 3, s14
    v_mul_u32_u24 v8, 1280, v162
    v_lshl_add_u32 v8, v161, 2, v8
    s_mul_i32 s86, s5, 160
    s_lshl_b32 s15, s4, 5
    s_add_u32 s86, s86, s15
    v_add_u32 v8, s86, v8
    v_add_u32 v9, -3840, v8
    v_add_u32 v10, -2560, v8
    v_add_u32 v11, -1280, v8
    s_lshl_b32 s15, s86, 2
    v_lshl_add_u32 v13, v161, 4, s15
    v_sub_u32 v14, 7, v161
    v_lshl_add_u32 v14, v14, 3, v160
    v_lshlrev_b32 v14, 2, v14
    s_lshl_b32 s15, s86, 11
    s_add_u32 s15, s15, 2789248
    s_lshl_b32 s14, s14, 1
    s_sub_u32 s15, s15, s14
    v_lshlrev_b32 v15, 13, v160
    v_lshl_add_u32 v15, v161, 4, v15
    v_add_u32 v15, s15, v15
    v_add_u32 v16, 32, v9
    v_add_u32 v17, 32, v10
    v_add_u32 v18, 32, v11
    s_setprio 3
    s_mov_b32 s56, s16
    s_and_b32 s57, s17, 0xffff
    s_mov_b32 s58, 2621440
    s_mov_b32 s59, 0x20000
    s_mov_b32 s60, s36
    s_and_b32 s61, s37, 0xffff
    s_mov_b32 s62, 819200
    s_mov_b32 s63, 0x20000
    s_mov_b32 s31, 0
    s_cmp_eq_u32 s4, 2
    s_cselect_b32 s31, 1, s31
    s_cmp_eq_u32 s4, 3
    s_cselect_b32 s14, s7, 0
    s_lshl_b32 s14, s14, 1
    s_or_b32 s31, s31, s14
    s_cmp_eq_u32 s31, 0
    s_cselect_b32 s30, 1, 0
    s_mov_b32 s14, 0
    s_cmp_eq_u32 s4, 1
    s_cselect_b32 s14, 1, s14
    s_cmp_eq_u32 s4, 3
    s_cselect_b32 s14, 2, s14
    s_cmp_eq_u32 s4, 2
    s_cselect_b32 s15, 1, s14
    s_mov_b32 s28, s8
    s_cmp_eq_u32 s14, 1
    s_cselect_b32 s28, s9, s28
    s_cmp_eq_u32 s14, 2
    s_cselect_b32 s28, s10, s28
    s_cmp_eq_u32 s4, 2
    s_cselect_b32 s29, s9, s28
    s_mul_i32 s20, s14, 19712
    s_add_u32 s20, s20, 84224
    s_add_u32 s21, s20, 5120
    s_mul_i32 s22, s15, 19712
    s_add_u32 s22, s22, 84224
    s_add_u32 s23, s22, 5120
    s_add_u32 s22, s22, 2172
    s_add_u32 s20, s20, 124
    s_cmp_eq_u32 s30, 1
    s_cselect_b32 s14, 0, 2048
    s_cselect_b32 s15, 2304, 0
    s_add_u32 s20, s20, s14
    s_add_u32 s23, s23, s15
    v_and_b32 v160, 31, v0
    v_lshrrev_b32 v161, 5, v0
    v_lshlrev_b32 v2, 4, v161
    v_lshlrev_b32 v162, 2, v160
    v_sub_u32 v2, v2, v162
    v_add_u32 v2, s20, v2
    v_lshrrev_b32 v162, 1, v160
    v_mul_u32_u24 v3, 144, v162
    v_and_b32 v163, 1, v0
    v_mul_u32_u24 v163, 7296, v163
    v_add_u32 v3, v3, v163
    v_lshl_add_u32 v3, v161, 4, v3
    v_add_u32 v3, s21, v3
    s_sub_u32 s22, s22, s20
    s_sub_u32 s22, s22, 2048
    s_sub_u32 s23, s23, s21
    s_sub_u32 s23, s23, 2304
    s_mul_i32 s20, s5, 327680
    s_add_u32 s20, s20, 6225920
    s_mul_i32 s21, s30, 163840
    s_add_u32 s21, s21, s20
    v_and_b32 v5, 7, v0
    v_lshlrev_b32 v5, 2, v5
    v_add_u32 v5, 10240, v5
    v_bfe_u32 v162, v0, 4, 1
    v_lshlrev_b32 v1, 7, v162
    v_and_b32 v162, 7, v0
    v_lshl_add_u32 v1, v162, 4, v1
    v_bfe_u32 v162, v0, 3, 1
    v_lshl_add_u32 v1, v162, 3, v1
    s_mov_b32 s33, s4
    s_mov_b32 s34, 0
    s_lshl_b32 s88, s5, 2
    s_lshr_b32 s14, s2, 6
    s_add_u32 s88, s88, s14
    s_and_b32 s89, s6, 7
    s_mul_i32 s14, s88, 200
    s_mul_i32 s15, s4, 50
    s_add_u32 s14, s14, s15
    v_add_u32 v160, s14, v0
    v_lshrrev_b32 v161, 4, v160
    v_mul_u32_u24 v161, 205, v161
    v_lshrrev_b32 v161, 10, v161
    v_mul_u32_u24 v162, 80, v161
    v_sub_u32 v160, v160, v162
    s_mul_i32 s14, s89, 80
    v_add_u32 v160, s14, v160
    s_mov_b32 s32, 0
    s_mov_b32 s85, 0
    s_mul_i32 s86, s89, 102400
    s_add_u32 s86, s86, 5406720
    v_mul_u32_u24 v162, 205, v161
    v_lshrrev_b32 v162, 11, v162
    v_mul_u32_u24 v163, 10, v162
    v_sub_u32 v163, v161, v163
    v_mul_u32_u24 v162, 80, v162
    v_and_b32 v164, 3, v163
    v_mul_u32_u24 v164, 20, v164
    v_lshrrev_b32 v165, 2, v163
    v_lshl_add_u32 v164, v165, 3, v164
    v_add_u32 v165, 4, v164
    v_cmp_le_u32 vcc, 8, v163
    v_mul_u32_u24 v166, 40, v163
    v_add_u32 v167, -304, v166
    v_add_u32 v166, -284, v166
    v_cndmask_b32 v164, v164, v167, vcc
    v_cndmask_b32 v165, v165, v166, vcc
    v_add_u32 v164, v164, v162
    v_add_u32 v165, v165, v162
    v_mul_u32_u24 v164, 1280, v164
    v_mul_u32_u24 v165, 1280, v165
    v_lshl_add_u32 v164, v160, 1, v164
    v_lshl_add_u32 v165, v160, 1, v165
    v_lshrrev_b32 v162, 2, v160
    v_mul_u32_u24 v163, 205, v162
    v_lshrrev_b32 v163, 10, v163
    v_mul_u32_u24 v166, 5, v163
    v_sub_u32 v162, v162, v166
    v_lshrrev_b32 v166, 2, v163
    v_mul_u32_u24 v166, 20, v166
    v_lshrrev_b32 v167, 2, v161
    v_add_u32 v166, v166, v167
    v_mad_u32_u24 v166, v166, 5, v162
    v_lshlrev_b32 v166, 10, v166
    v_and_b32 v167, 3, v161
    v_lshl_add_u32 v166, v167, 8, v166
    v_and_b32 v167, 3, v163
    v_lshl_add_u32 v166, v167, 6, v166
    v_and_b32 v167, 3, v160
    v_lshl_add_u32 v166, v167, 4, v166
    v_add_u32 v166, 5406720, v166
    s_lshl_b32 s14, s6, 6
    s_lshl_b32 s15, s4, 4
    s_add_u32 s14, s14, s15
    v_lshrrev_b32 v160, 2, v0
    v_add_u32 v160, s14, v160
    v_mul_u32_u24 v160, 1280, v160
    v_and_b32 v161, 3, v0
    v_mad_u32_u24 v160, v161, 52, v160
    s_mul_i32 s14, s5, 160
    v_add_u32 v167, s14, v160
    v_lshrrev_b32 v160, 3, v0
    v_and_b32 v161, 7, v0
    s_lshl_b32 s14, s4, 1
    s_add_u32 s14, s14, 0
    v_lshrrev_b32 v162, 2, v161
    v_add_u32 v162, s14, v162
    v_lshl_add_u32 v162, v160, 1, v162
    v_mul_u32_u24 v160, 1280, v160
    v_and_b32 v161, 3, v161
    v_lshl_add_u32 v160, v161, 2, v160
    v_add_u32 v161, 0, v162
    v_mul_u32_u24 v163, 205, v161
    v_lshrrev_b32 v163, 11, v163
    v_mul_u32_u24 v163, 10, v163
    v_sub_u32 v161, v161, v163
    v_lshl_add_u32 v19, v161, 4, v160
    v_add_u32 v19, 102400, v19
    v_add_u32 v161, 8, v162
    v_mul_u32_u24 v163, 205, v161
    v_lshrrev_b32 v163, 11, v163
    v_mul_u32_u24 v163, 10, v163
    v_sub_u32 v161, v161, v163
    v_lshl_add_u32 v20, v161, 4, v160
    v_add_u32 v20, 101920, v20
    v_lshrrev_b32 v160, 3, v0
    v_and_b32 v161, 7, v0
    s_lshl_b32 s14, s4, 1
    s_add_u32 s14, s14, 2
    v_lshrrev_b32 v162, 2, v161
    v_add_u32 v162, s14, v162
    v_lshl_add_u32 v162, v160, 1, v162
    v_mul_u32_u24 v160, 1280, v160
    v_and_b32 v161, 3, v161
    v_lshl_add_u32 v160, v161, 2, v160
    v_add_u32 v161, 0, v162
    v_mul_u32_u24 v163, 205, v161
    v_lshrrev_b32 v163, 11, v163
    v_mul_u32_u24 v163, 10, v163
    v_sub_u32 v161, v161, v163
    v_lshl_add_u32 v21, v161, 4, v160
    v_add_u32 v21, 102400, v21
    v_add_u32 v161, 8, v162
    v_mul_u32_u24 v163, 205, v161
    v_lshrrev_b32 v163, 11, v163
    v_mul_u32_u24 v163, 10, v163
    v_sub_u32 v161, v161, v163
    v_lshl_add_u32 v22, v161, 4, v160
    v_add_u32 v22, 101920, v22
    global_load_dwordx4 v[44:47], v13, s[90:91] offset:0
    s_mov_b64 exec, 0xff
    buffer_load_dword v24, v9, s[80:83], 0 offen
    buffer_load_dword v25, v10, s[80:83], 0 offen
    buffer_load_dword v26, v11, s[80:83], 0 offen
    s_mov_b64 exec, -1
    s_cmp_eq_u32 s4, 3
    s_cbranch_scc0 K2_H_S1
    global_load_dwordx4 v[140:143], v13, s[90:91] offset:128
    s_mov_b64 exec, 0xff
    buffer_load_dword v120, v16, s[80:83], 0 offen
    buffer_load_dword v121, v17, s[80:83], 0 offen
    buffer_load_dword v122, v18, s[80:83], 0 offen
    s_mov_b64 exec, -1
K2_H_S1:
    s_and_b32 s15, s4, 1
    s_lshl_b32 s15, s15, 3
    s_sub_u32 s15, 20, s15
    v_add_u32 v160, 0, v0
    v_mul_u32_u24 v161, 6554, v160
    v_lshrrev_b32 v161, 16, v161
    v_mul_u32_u24 v162, 10, v161
    v_sub_u32 v160, v160, v162
    v_add_u32 v160, s15, v160
    v_lshrrev_b32 v162, 3, v161
    v_lshlrev_b32 v162, 1, v162
    v_sub_u32 v160, v160, v162
    v_mul_u32_u24 v162, 205, v160
    v_lshrrev_b32 v162, 11, v162
    v_mul_u32_u24 v162, 10, v162
    v_sub_u32 v160, v160, v162
    v_mul_u32_u24 v161, 1280, v161
    v_lshl_add_u32 v72, v160, 4, v161
    v_add_u32 v160, 64, v0
    v_mul_u32_u24 v161, 6554, v160
    v_lshrrev_b32 v161, 16, v161
    v_mul_u32_u24 v162, 10, v161
    v_sub_u32 v160, v160, v162
    v_add_u32 v160, s15, v160
    v_lshrrev_b32 v162, 3, v161
    v_lshlrev_b32 v162, 1, v162
    v_sub_u32 v160, v160, v162
    v_mul_u32_u24 v162, 205, v160
    v_lshrrev_b32 v162, 11, v162
    v_mul_u32_u24 v162, 10, v162
    v_sub_u32 v160, v160, v162
    v_mul_u32_u24 v161, 1280, v161
    v_lshl_add_u32 v73, v160, 4, v161
    v_add_u32 v160, 128, v0
    v_mul_u32_u24 v161, 6554, v160
    v_lshrrev_b32 v161, 16, v161
    v_mul_u32_u24 v162, 10, v161
    v_sub_u32 v160, v160, v162
    v_add_u32 v160, s15, v160
    v_lshrrev_b32 v162, 3, v161
    v_lshlrev_b32 v162, 1, v162
    v_sub_u32 v160, v160, v162
    v_mul_u32_u24 v162, 205, v160
    v_lshrrev_b32 v162, 11, v162
    v_mul_u32_u24 v162, 10, v162
    v_sub_u32 v160, v160, v162
    v_mul_u32_u24 v161, 1280, v161
    v_lshl_add_u32 v74, v160, 4, v161
    v_add_u32 v160, 192, v0
    v_mul_u32_u24 v161, 6554, v160
    v_lshrrev_b32 v161, 16, v161
    v_mul_u32_u24 v162, 10, v161
    v_sub_u32 v160, v160, v162
    v_add_u32 v160, s15, v160
    v_lshrrev_b32 v162, 3, v161
    v_lshlrev_b32 v162, 1, v162
    v_sub_u32 v160, v160, v162
    v_mul_u32_u24 v162, 205, v160
    v_lshrrev_b32 v162, 11, v162
    v_mul_u32_u24 v162, 10, v162
    v_sub_u32 v160, v160, v162
    v_mul_u32_u24 v161, 1280, v161
    v_lshl_add_u32 v75, v160, 4, v161
    v_add_u32 v160, 256, v0
    v_mul_u32_u24 v161, 6554, v160
    v_lshrrev_b32 v161, 16, v161
    v_mul_u32_u24 v162, 10, v161
    v_sub_u32 v160, v160, v162
    v_add_u32 v160, s15, v160
    v_lshrrev_b32 v162, 3, v161
    v_lshlrev_b32 v162, 1, v162
    v_sub_u32 v160, v160, v162
    v_mul_u32_u24 v162, 205, v160
    v_lshrrev_b32 v162, 11, v162
    v_mul_u32_u24 v162, 10, v162
    v_sub_u32 v160, v160, v162
    v_mul_u32_u24 v161, 1280, v161
    v_lshl_add_u32 v76, v160, 4, v161
    s_cmp_lt_u32 s4, 2
    s_cselect_b32 s80, s80, s98
    s_cselect_b32 s81, s81, s99
    s_mul_i32 s84, s6, 81920
    s_mul_i32 s14, s5, 160
    s_add_u32 s84, s84, s14
    s_and_b32 s14, s4, 1
    s_mul_i32 s14, s14, 40960
    s_add_u32 s84, s84, s14
    s_mul_i32 s43, s4, 5120
    s_add_u32 s43, s43, 102400
    s_cmp_eq_u32 s4, 0
    s_cbranch_scc1 K2_H_B1
    s_barrier
K2_H_B1:
    s_barrier
    s_barrier
    s_add_u32 m0, s43, 0
    s_nop 0
    buffer_load_dwordx4 v72, s[80:83], s84 offen lds
    s_add_u32 m0, s43, 1024
    s_nop 0
    buffer_load_dwordx4 v73, s[80:83], s84 offen lds
    s_add_u32 m0, s43, 2048
    s_nop 0
    buffer_load_dwordx4 v74, s[80:83], s84 offen lds
    s_add_u32 m0, s43, 3072
    s_nop 0
    buffer_load_dwordx4 v75, s[80:83], s84 offen lds
    s_add_u32 m0, s43, 4096
    s_nop 0
    buffer_load_dwordx4 v76, s[80:83], s84 offen lds
    v_mov_b32 v144, v56
    v_mov_b32 v145, v57
    v_mov_b32 v146, v58
    v_mov_b32 v147, v59
    v_mov_b32 v148, v60
    v_mov_b32 v149, v61
    v_mov_b32 v150, v62
    v_mov_b32 v151, v63
    v_mov_b32 v152, v64
    v_mov_b32 v153, v65
    v_mov_b32 v154, v66
    v_mov_b32 v155, v67
    v_mov_b32 v156, v68
    v_mov_b32 v157, v69
    v_mov_b32 v158, v70
    v_mov_b32 v159, v71
    s_lshl_b32 s14, s4, 2
    s_add_u32 s14, s14, 10400
    v_mov_b32 v160, s14
    v_mov_b32 v161, 1
    s_waitcnt vmcnt(0)
    ds_write_b32 v160, v161
K2_Y3:
    ds_read_b32 v161, v5 offset:160
    s_waitcnt lgkmcnt(0)
    v_cmp_gt_u32 vcc, 1, v161
    s_nop 3
    s_and_b32 s14, vcc_lo, 15
    s_cbranch_scc0 K2_Y3_OK
    s_sleep 1
    s_branch K2_Y3
K2_Y3_OK:
    s_mov_b32 exec_lo, 0xffffff00
    ds_read_b32 v24, v20 offset:0
    ds_read_b32 v25, v20 offset:160
    ds_read_b32 v26, v20 offset:320
    s_mov_b64 exec, -1
    ds_read_b32 v27, v19 offset:0
    ds_read_b32 v28, v19 offset:160
    ds_read_b32 v29, v19 offset:320
    ds_read_b32 v30, v19 offset:480
    ds_read_b32 v31, v19 offset:640
    ds_read_b32 v32, v19 offset:800
    ds_read_b32 v33, v19 offset:960
    ds_read_b32 v34, v19 offset:1120
    s_waitcnt lgkmcnt(4)
    ds_read_b32 v36, v19 offset:10240
    ds_read_b32 v37, v19 offset:10400
    ds_read_b32 v38, v19 offset:10560
    ds_read_b32 v39, v19 offset:10720
    ds_read_b32 v40, v19 offset:10880
    ds_read_b32 v41, v19 offset:11040
    ds_read_b32 v42, v19 offset:11200
    ds_read_b32 v43, v19 offset:11360
    s_cmp_eq_u32 s4, 3
    s_cbranch_scc0 K2_L_GO
    s_waitcnt lgkmcnt(0)
    s_mov_b32 exec_lo, 0xffffff00
    ds_read_b32 v120, v22 offset:0
    ds_read_b32 v121, v22 offset:160
    ds_read_b32 v122, v22 offset:320
    s_mov_b64 exec, -1
    ds_read_b32 v123, v21 offset:0
    ds_read_b32 v124, v21 offset:160
    ds_read_b32 v125, v21 offset:320
    ds_read_b32 v126, v21 offset:480
    ds_read_b32 v127, v21 offset:640
    ds_read_b32 v128, v21 offset:800
    ds_read_b32 v129, v21 offset:960
    ds_read_b32 v130, v21 offset:1120
    s_waitcnt lgkmcnt(4)
    ds_read_b32 v132, v21 offset:10240
    ds_read_b32 v133, v21 offset:10400
    ds_read_b32 v134, v21 offset:10560
    ds_read_b32 v135, v21 offset:10720
    ds_read_b32 v136, v21 offset:10880
    ds_read_b32 v137, v21 offset:11040
    ds_read_b32 v138, v21 offset:11200
    ds_read_b32 v139, v21 offset:11360
K2_L_GO:
    s_waitcnt vmcnt(0) lgkmcnt(0)
    v_lshlrev_b32 v56, 16, v44
    v_lshlrev_b32 v57, 16, v46
    v_and_b32 v58, 0xffff0000, v44
    v_and_b32 v59, 0xffff0000, v46
    v_lshlrev_b32 v60, 16, v45
    v_lshlrev_b32 v61, 16, v47
    v_and_b32 v62, 0xffff0000, v45
    v_and_b32 v63, 0xffff0000, v47
    v_lshlrev_b32 v64, 16, v24
    v_and_b32 v65, 0xffff0000, v24
    v_lshlrev_b32 v66, 16, v25
    v_and_b32 v67, 0xffff0000, v25
    v_lshlrev_b32 v68, 16, v26
    v_and_b32 v69, 0xffff0000, v26
    v_lshlrev_b32 v70, 16, v27
    v_and_b32 v71, 0xffff0000, v27
    v_lshlrev_b32 v72, 16, v28
    v_and_b32 v73, 0xffff0000, v28
    v_lshlrev_b32 v74, 16, v29
    v_and_b32 v75, 0xffff0000, v29
    v_lshlrev_b32 v76, 16, v30
    v_and_b32 v77, 0xffff0000, v30
    v_lshlrev_b32 v78, 16, v31
    v_and_b32 v79, 0xffff0000, v31
    v_lshlrev_b32 v80, 16, v32
    v_and_b32 v81, 0xffff0000, v32
    v_lshlrev_b32 v82, 16, v33
    v_and_b32 v83, 0xffff0000, v33
    v_lshlrev_b32 v84, 16, v34
    v_and_b32 v85, 0xffff0000, v34
    v_lshlrev_b32 v88, 16, v36
    v_and_b32 v89, 0xffff0000, v36
    v_lshlrev_b32 v90, 16, v37
    v_and_b32 v91, 0xffff0000, v37
    v_lshlrev_b32 v92, 16, v38
    v_and_b32 v93, 0xffff0000, v38
    v_lshlrev_b32 v94, 16, v39
    v_and_b32 v95, 0xffff0000, v39
    v_lshlrev_b32 v96, 16, v40
    v_and_b32 v97, 0xffff0000, v40
    v_lshlrev_b32 v98, 16, v41
    v_and_b32 v99, 0xffff0000, v41
    v_lshlrev_b32 v100, 16, v42
    v_and_b32 v101, 0xffff0000, v42
    v_lshlrev_b32 v102, 16, v43
    v_and_b32 v103, 0xffff0000, v43
    v_pk_mul_f32 v[104:105], v[64:65], v[62:63]
    v_pk_mul_f32 v[106:107], v[66:67], v[62:63]
    v_pk_mul_f32 v[108:109], v[68:69], v[62:63]
    v_pk_mul_f32 v[110:111], v[70:71], v[62:63]
    v_pk_mul_f32 v[112:113], v[72:73], v[62:63]
    v_pk_mul_f32 v[114:115], v[74:75], v[62:63]
    v_pk_mul_f32 v[116:117], v[76:77], v[62:63]
    v_pk_mul_f32 v[118:119], v[78:79], v[62:63]
    v_pk_fma_f32 v[104:105], v[66:67], v[60:61], v[104:105]
    v_pk_fma_f32 v[106:107], v[68:69], v[60:61], v[106:107]
    v_pk_fma_f32 v[108:109], v[70:71], v[60:61], v[108:109]
    v_pk_fma_f32 v[110:111], v[72:73], v[60:61], v[110:111]
    v_pk_fma_f32 v[112:113], v[74:75], v[60:61], v[112:113]
    v_pk_fma_f32 v[114:115], v[76:77], v[60:61], v[114:115]
    v_pk_fma_f32 v[116:117], v[78:79], v[60:61], v[116:117]
    v_pk_fma_f32 v[118:119], v[80:81], v[60:61], v[118:119]
    v_pk_fma_f32 v[104:105], v[68:69], v[58:59], v[104:105]
    v_pk_fma_f32 v[106:107], v[70:71], v[58:59], v[106:107]
    v_pk_fma_f32 v[108:109], v[72:73], v[58:59], v[108:109]
    v_pk_fma_f32 v[110:111], v[74:75], v[58:59], v[110:111]
    v_pk_fma_f32 v[112:113], v[76:77], v[58:59], v[112:113]
    v_pk_fma_f32 v[114:115], v[78:79], v[58:59], v[114:115]
    v_pk_fma_f32 v[116:117], v[80:81], v[58:59], v[116:117]
    v_pk_fma_f32 v[118:119], v[82:83], v[58:59], v[118:119]
    v_pk_fma_f32 v[104:105], v[70:71], v[56:57], v[104:105]
    v_pk_fma_f32 v[106:107], v[72:73], v[56:57], v[106:107]
    v_pk_fma_f32 v[108:109], v[74:75], v[56:57], v[108:109]
    v_pk_fma_f32 v[110:111], v[76:77], v[56:57], v[110:111]
    v_pk_fma_f32 v[112:113], v[78:79], v[56:57], v[112:113]
    v_pk_fma_f32 v[114:115], v[80:81], v[56:57], v[114:115]
    v_pk_fma_f32 v[116:117], v[82:83], v[56:57], v[116:117]
    v_pk_fma_f32 v[118:119], v[84:85], v[56:57], v[118:119]
    v_pk_mul_f32 v[104:105], v[104:105], v[88:89]
    v_pk_mul_f32 v[106:107], v[106:107], v[90:91]
    v_pk_mul_f32 v[108:109], v[108:109], v[92:93]
    v_pk_mul_f32 v[110:111], v[110:111], v[94:95]
    v_pk_mul_f32 v[112:113], v[112:113], v[96:97]
    v_pk_mul_f32 v[114:115], v[114:115], v[98:99]
    v_pk_mul_f32 v[116:117], v[116:117], v[100:101]
    v_pk_mul_f32 v[118:119], v[118:119], v[102:103]
    v_cvt_pk_bf16_f32 v24, v118, v116
    v_cvt_pk_bf16_f32 v25, v114, v112
    v_cvt_pk_bf16_f32 v26, v110, v108
    v_cvt_pk_bf16_f32 v27, v106, v104
    v_cvt_pk_bf16_f32 v28, v119, v117
    v_cvt_pk_bf16_f32 v29, v115, v113
    v_cvt_pk_bf16_f32 v30, v111, v109
    v_cvt_pk_bf16_f32 v31, v107, v105
    ds_bpermute_b32 v32, v14, v24
    ds_bpermute_b32 v33, v14, v25
    ds_bpermute_b32 v34, v14, v26
    ds_bpermute_b32 v35, v14, v27
    ds_bpermute_b32 v36, v14, v28
    ds_bpermute_b32 v37, v14, v29
    ds_bpermute_b32 v38, v14, v30
    ds_bpermute_b32 v39, v14, v31
    s_mov_b32 s14, 0
    s_mov_b32 s15, 4096
    s_waitcnt lgkmcnt(0)
    buffer_store_dwordx4 v[32:35], v15, s[44:47], s14 offen sc1
    buffer_store_dwordx4 v[36:39], v15, s[44:47], s15 offen sc1
    s_cmp_eq_u32 s4, 3
    s_cbranch_scc0 K2_L_GO2
    v_lshlrev_b32 v56, 16, v140
    v_lshlrev_b32 v57, 16, v142
    v_and_b32 v58, 0xffff0000, v140
    v_and_b32 v59, 0xffff0000, v142
    v_lshlrev_b32 v60, 16, v141
    v_lshlrev_b32 v61, 16, v143
    v_and_b32 v62, 0xffff0000, v141
    v_and_b32 v63, 0xffff0000, v143
    v_lshlrev_b32 v64, 16, v120
    v_and_b32 v65, 0xffff0000, v120
    v_lshlrev_b32 v66, 16, v121
    v_and_b32 v67, 0xffff0000, v121
    v_lshlrev_b32 v68, 16, v122
    v_and_b32 v69, 0xffff0000, v122
    v_lshlrev_b32 v70, 16, v123
    v_and_b32 v71, 0xffff0000, v123
    v_lshlrev_b32 v72, 16, v124
    v_and_b32 v73, 0xffff0000, v124
    v_lshlrev_b32 v74, 16, v125
    v_and_b32 v75, 0xffff0000, v125
    v_lshlrev_b32 v76, 16, v126
    v_and_b32 v77, 0xffff0000, v126
    v_lshlrev_b32 v78, 16, v127
    v_and_b32 v79, 0xffff0000, v127
    v_lshlrev_b32 v80, 16, v128
    v_and_b32 v81, 0xffff0000, v128
    v_lshlrev_b32 v82, 16, v129
    v_and_b32 v83, 0xffff0000, v129
    v_lshlrev_b32 v84, 16, v130
    v_and_b32 v85, 0xffff0000, v130
    v_lshlrev_b32 v88, 16, v132
    v_and_b32 v89, 0xffff0000, v132
    v_lshlrev_b32 v90, 16, v133
    v_and_b32 v91, 0xffff0000, v133
    v_lshlrev_b32 v92, 16, v134
    v_and_b32 v93, 0xffff0000, v134
    v_lshlrev_b32 v94, 16, v135
    v_and_b32 v95, 0xffff0000, v135
    v_lshlrev_b32 v96, 16, v136
    v_and_b32 v97, 0xffff0000, v136
    v_lshlrev_b32 v98, 16, v137
    v_and_b32 v99, 0xffff0000, v137
    v_lshlrev_b32 v100, 16, v138
    v_and_b32 v101, 0xffff0000, v138
    v_lshlrev_b32 v102, 16, v139
    v_and_b32 v103, 0xffff0000, v139
    v_pk_mul_f32 v[104:105], v[64:65], v[62:63]
    v_pk_mul_f32 v[106:107], v[66:67], v[62:63]
    v_pk_mul_f32 v[108:109], v[68:69], v[62:63]
    v_pk_mul_f32 v[110:111], v[70:71], v[62:63]
    v_pk_mul_f32 v[112:113], v[72:73], v[62:63]
    v_pk_mul_f32 v[114:115], v[74:75], v[62:63]
    v_pk_mul_f32 v[116:117], v[76:77], v[62:63]
    v_pk_mul_f32 v[118:119], v[78:79], v[62:63]
    v_pk_fma_f32 v[104:105], v[66:67], v[60:61], v[104:105]
    v_pk_fma_f32 v[106:107], v[68:69], v[60:61], v[106:107]
    v_pk_fma_f32 v[108:109], v[70:71], v[60:61], v[108:109]
    v_pk_fma_f32 v[110:111], v[72:73], v[60:61], v[110:111]
    v_pk_fma_f32 v[112:113], v[74:75], v[60:61], v[112:113]
    v_pk_fma_f32 v[114:115], v[76:77], v[60:61], v[114:115]
    v_pk_fma_f32 v[116:117], v[78:79], v[60:61], v[116:117]
    v_pk_fma_f32 v[118:119], v[80:81], v[60:61], v[118:119]
    v_pk_fma_f32 v[104:105], v[68:69], v[58:59], v[104:105]
    v_pk_fma_f32 v[106:107], v[70:71], v[58:59], v[106:107]
    v_pk_fma_f32 v[108:109], v[72:73], v[58:59], v[108:109]
    v_pk_fma_f32 v[110:111], v[74:75], v[58:59], v[110:111]
    v_pk_fma_f32 v[112:113], v[76:77], v[58:59], v[112:113]
    v_pk_fma_f32 v[114:115], v[78:79], v[58:59], v[114:115]
    v_pk_fma_f32 v[116:117], v[80:81], v[58:59], v[116:117]
    v_pk_fma_f32 v[118:119], v[82:83], v[58:59], v[118:119]
    v_pk_fma_f32 v[104:105], v[70:71], v[56:57], v[104:105]
    v_pk_fma_f32 v[106:107], v[72:73], v[56:57], v[106:107]
    v_pk_fma_f32 v[108:109], v[74:75], v[56:57], v[108:109]
    v_pk_fma_f32 v[110:111], v[76:77], v[56:57], v[110:111]
    v_pk_fma_f32 v[112:113], v[78:79], v[56:57], v[112:113]
    v_pk_fma_f32 v[114:115], v[80:81], v[56:57], v[114:115]
    v_pk_fma_f32 v[116:117], v[82:83], v[56:57], v[116:117]
    v_pk_fma_f32 v[118:119], v[84:85], v[56:57], v[118:119]
    v_pk_mul_f32 v[104:105], v[104:105], v[88:89]
    v_pk_mul_f32 v[106:107], v[106:107], v[90:91]
    v_pk_mul_f32 v[108:109], v[108:109], v[92:93]
    v_pk_mul_f32 v[110:111], v[110:111], v[94:95]
    v_pk_mul_f32 v[112:113], v[112:113], v[96:97]
    v_pk_mul_f32 v[114:115], v[114:115], v[98:99]
    v_pk_mul_f32 v[116:117], v[116:117], v[100:101]
    v_pk_mul_f32 v[118:119], v[118:119], v[102:103]
    v_cvt_pk_bf16_f32 v120, v118, v116
    v_cvt_pk_bf16_f32 v121, v114, v112
    v_cvt_pk_bf16_f32 v122, v110, v108
    v_cvt_pk_bf16_f32 v123, v106, v104
    v_cvt_pk_bf16_f32 v124, v119, v117
    v_cvt_pk_bf16_f32 v125, v115, v113
    v_cvt_pk_bf16_f32 v126, v111, v109
    v_cvt_pk_bf16_f32 v127, v107, v105
    ds_bpermute_b32 v128, v14, v120
    ds_bpermute_b32 v129, v14, v121
    ds_bpermute_b32 v130, v14, v122
    ds_bpermute_b32 v131, v14, v123
    ds_bpermute_b32 v132, v14, v124
    ds_bpermute_b32 v133, v14, v125
    ds_bpermute_b32 v134, v14, v126
    ds_bpermute_b32 v135, v14, v127
    s_mov_b32 s14, 65536
    s_mov_b32 s15, 69632
    s_waitcnt lgkmcnt(0)
    buffer_store_dwordx4 v[128:131], v15, s[44:47], s14 offen sc1
    buffer_store_dwordx4 v[132:135], v15, s[44:47], s15 offen sc1
K2_L_GO2:
    s_lshl_b32 s14, s5, 3
    s_add_u32 s14, s14, s4
    s_lshl_b32 s14, s14, 7
    s_add_u32 s14, s14, 11481088
    v_lshl_add_u32 v19, v0, 7, s14
    v_mov_b32 v20, 1
    s_cmp_eq_u32 s4, 3
    s_cselect_b32 s43, 3, 1
K2_PG:
    ds_read_b32 v161, v5 offset:224
    s_waitcnt lgkmcnt(0)
    v_cmp_gt_u32 vcc, 1, v161
    s_nop 3
    s_and_b32 s14, vcc_lo, 240
    s_cbranch_scc0 K2_PG_OK
    s_sleep 2
    s_branch K2_PG
K2_PG_OK:
    s_setprio 0
    v_mov_b32 v40, -1
    v_mov_b32 v41, -1
    v_mov_b32 v42, -1
    v_mov_b32 v43, -1
    s_mul_i32 s14, s4, 20480
    s_add_u32 s14, s14, s87
    s_add_u32 s14, s14, 8847360
    s_add_u32 s15, s14, 10240
    buffer_store_dwordx4 v[40:43], v4, s[44:47], s14 offen sc1
    buffer_store_dwordx4 v[40:43], v4, s[44:47], s15 offen sc1
    s_mov_b64 exec, 0xffff
    buffer_store_dwordx4 v[40:43], v4, s[44:47], s14 offen offset:1024 sc1
    buffer_store_dwordx4 v[40:43], v4, s[44:47], s15 offen offset:1024 sc1
    s_mov_b64 exec, -1
    s_mul_i32 s14, s6, 10240
    s_add_u32 s14, s14, s20
    s_mul_i32 s15, s4, 2560
    s_add_u32 s14, s14, s15
    buffer_store_dwordx4 v[40:43], v4, s[44:47], s14 offen sc1
    buffer_store_dwordx4 v[40:43], v4, s[44:47], s14 offen offset:1024 sc1
    s_mov_b32 exec_hi, 0
    buffer_store_dwordx4 v[40:43], v4, s[44:47], s14 offen offset:2048 sc1
    s_mov_b64 exec, -1
    s_setprio 3
    s_lshl_b32 s14, s4, 2
    s_add_u32 s14, s14, 10384
    v_mov_b32 v160, s14
    s_waitcnt vmcnt(0)
    ds_write_b32 v160, v20
K2_L_PA:
    ds_read_b32 v161, v5 offset:128
    s_waitcnt lgkmcnt(0)
    v_cmp_gt_u32 vcc, 1, v161
    s_nop 3
    s_and_b32 s14, vcc_lo, 240
    s_cbranch_scc0 K2_L_PA_OK
    s_sleep 1
    s_branch K2_L_PA
K2_L_PA_OK:
    s_mov_b32 exec_hi, 0
    s_mov_b32 exec_lo, s43
    buffer_atomic_add v20, v19, s[44:47], 0 offen sc1
    s_mov_b64 exec, -1
K2_L_D:
    ds_read_b32 v6, v5 offset:16
    s_waitcnt lgkmcnt(0)
    v_readfirstlane_b32 s14, v6
    s_nop 3
    s_cmp_ge_u32 s14, 1
    s_cbranch_scc1 K2_L_D2
    s_sleep 2
    s_branch K2_L_D
K2_L_D2:
    s_setprio 0
    s_cmp_eq_u32 s4, 3
    s_cbranch_scc1 K2_L_G
    buffer_load_ushort v48, v51, s[52:55], 0 offen
    global_load_ushort v49, v159, s[26:27]
    s_add_u32 m0, s13, 12416
    s_nop 0
    buffer_load_dwordx4 v145, s[52:55], 0 offen lds
    s_add_u32 m0, s13, 13424
    s_nop 0
    buffer_load_dwordx4 v147, s[52:55], 0 offen lds
    s_add_u32 m0, s13, 14432
    s_nop 0
    buffer_load_dwordx4 v149, s[52:55], 0 offen lds
    s_add_u32 m0, s13, 15440
    s_nop 0
    buffer_load_dwordx4 v151, s[52:55], 0 offen lds
    s_add_u32 m0, s13, 16448
    s_nop 0
    buffer_load_dwordx4 v153, s[52:55], 0 offen lds
    s_add_u32 m0, s13, 17456
    s_nop 0
    buffer_load_dwordx4 v155, s[52:55], 0 offen lds
    s_add_u32 m0, s13, 18464
    s_nop 0
    buffer_load_dwordx4 v157, s[52:55], 0 offen lds
    s_add_u32 m0, s13, 5120
    s_nop 0
    buffer_load_dwordx4 v144, s[52:55], 0 offen lds
    s_add_u32 m0, s13, 6128
    s_nop 0
    buffer_load_dwordx4 v146, s[52:55], 0 offen lds
    s_add_u32 m0, s13, 7136
    s_nop 0
    buffer_load_dwordx4 v148, s[52:55], 0 offen lds
    s_add_u32 m0, s13, 8144
    s_nop 0
    buffer_load_dwordx4 v150, s[52:55], 0 offen lds
    s_add_u32 m0, s13, 9152
    s_nop 0
    buffer_load_dwordx4 v152, s[52:55], 0 offen lds
    s_add_u32 m0, s13, 10160
    s_nop 0
    buffer_load_dwordx4 v154, s[52:55], 0 offen lds
    s_add_u32 m0, s13, 11168
    s_nop 0
    buffer_load_dwordx4 v156, s[52:55], 0 offen lds
    s_add_u32 m0, s13, 4096
    s_nop 0
    buffer_load_dwordx4 v158, s[48:51], 0 offen lds
K2_L_G:
    s_setprio 3
    s_mov_b32 exec_hi, 0x3ffff
    buffer_load_ushort v152, v164, s[60:63], 0 offen offset:0
    buffer_load_ushort v153, v164, s[60:63], 0 offen offset:1280
    buffer_load_ushort v154, v164, s[60:63], 0 offen offset:2560
    buffer_load_ushort v155, v164, s[60:63], 0 offen offset:3840
    buffer_load_ushort v156, v165, s[60:63], 0 offen offset:0
    buffer_load_ushort v157, v165, s[60:63], 0 offen offset:1280
    buffer_load_ushort v158, v165, s[60:63], 0 offen offset:2560
    buffer_load_ushort v159, v165, s[60:63], 0 offen offset:3840
    s_mov_b64 exec, -1
    buffer_load_dword v167, v167, s[56:59], 0 offen
    s_getpc_b64 s[14:15]
K2_CTL:
    s_lshl_b32 s37, s4, 12
    v_lshl_add_u32 v162, v0, 6, s37
    v_min_u32 v162, KM_END-K2_CTL, v162
    global_load_dword v164, v162, s[14:15]
    s_cmp_eq_u32 s4, 3
    s_cbranch_scc1 K2_L_END
    s_mul_i32 s14, s5, 80
    s_sub_u32 s14, s11, s14
    s_lshr_b32 s14, s14, 4
    s_lshl_b32 s15, s5, 3
    s_add_u32 s14, s14, s15
    s_lshl_b32 s14, s14, 7
    s_add_u32 s42, s14, 11481088
    v_mov_b32 v8, 0
K2_UPOLL:
    buffer_load_dword v9, v8, s[44:47], s42 offen sc1
    ds_read_b32 v6, v5
    s_waitcnt lgkmcnt(0)
    v_cmp_ge_u32 vcc, s33, v6
    s_cmp_ge_u32 s33, 4
    s_cbranch_scc1 K2_SV2
    s_nop 1
    s_cbranch_vccnz K2_SV2
    s_call_b64 s[96:97], K2_REDUCE
    s_setprio 3
K2_SV2:
    s_waitcnt vmcnt(0)
    v_cmp_ne_u32 vcc, 32, v9
    s_nop 3
    s_cbranch_vccz K2_UGO
    s_sleep 6
    s_branch K2_UPOLL
K2_UGO:
    s_mov_b32 m0, s13
    s_nop 0
    buffer_load_dwordx4 v4, s[48:51], 0 offen offset:0 sc1 lds
    buffer_load_dwordx4 v4, s[48:51], 0 offen offset:1024 sc1 lds
    buffer_load_dwordx4 v4, s[48:51], 0 offen offset:2048 sc1 lds
    buffer_load_dwordx4 v4, s[48:51], 0 offen offset:3072 sc1 lds
    v_lshlrev_b32 v160, 16, v48
    v_lshlrev_b32 v49, 16, v49
    v_add_f32 v160, v160, v49
    v_cmp_eq_u32 vcc, 0, v51
    v_cvt_pk_bf16_f32 v160, v160, v160
    s_lshl_b32 s14, s4, 2
    s_add_u32 s14, s14, 10288
    v_cndmask_b32 v48, v48, v160, vcc
    v_mov_b32 v160, s14
    v_mov_b32 v161, 1
    s_mov_b64 exec, 0xff
    ds_write_b16 v50, v48
    s_mov_b64 exec, -1
    s_waitcnt vmcnt(0)
K2_L_END:
    s_lshl_b32 s14, s4, 2
    s_add_u32 s14, s14, 10288
    v_mov_b32 v160, s14
    v_mov_b32 v161, 1
    ds_write_b32 v160, v161
    v_mov_b64 v[8:9], 0
    v_mov_b64 v[10:11], 0
    v_mov_b64 v[12:13], 0
    v_mov_b64 v[14:15], 0
    v_mov_b64 v[16:17], 0
    v_mov_b64 v[18:19], 0
    v_mov_b64 v[20:21], 0
    v_mov_b64 v[22:23], 0
    s_waitcnt vmcnt(0)
    v_lshl_or_b32 v152, v153, 16, v152
    v_lshl_or_b32 v153, v155, 16, v154
    v_lshl_or_b32 v154, v157, 16, v156
    v_lshl_or_b32 v155, v159, 16, v158
    s_cmp_eq_u32 s32, 0
    s_cbranch_scc1 K2_NOG1
    s_call_b64 s[92:93], K2_POST
K2_NOG1:
    s_mov_b32 exec_hi, 0x3ffff
    buffer_store_dwordx4 v[152:155], v166, s[44:47], 0 offen sc1
    s_mov_b64 exec, -1
    s_lshl_b32 s32, s89, 7
    s_add_u32 s32, s32, 11476992
    v_and_b32 v160, 3, v0
    v_lshlrev_b32 v160, 2, v160
    v_add_u32 v160, 10288, v160
K2_WC:
    ds_read_b32 v6, v5
    ds_read_b32 v161, v160
    s_waitcnt lgkmcnt(0)
    v_cmp_ge_u32 vcc, s33, v6
    v_cmp_eq_u32 s[14:15], 0, v161
    s_nop 3
    s_cbranch_vccnz K2_WC2
    s_call_b64 s[96:97], K2_REDUCE
    s_setprio 3
    s_mov_b64 s[14:15], -1
    v_and_b32 v160, 3, v0
    v_lshlrev_b32 v160, 2, v160
    v_add_u32 v160, 10288, v160
K2_WC2:
    s_cmp_eq_u64 s[14:15], 0
    s_cbranch_scc1 K2_WC_OK
    s_sleep 2
    s_branch K2_WC
K2_WC_OK:
    s_setprio 1
K2_CONV:
    ds_read2_b32 v[24:25], v2 offset0:0 offset1:1
    ds_read2_b32 v[26:27], v2 offset0:2 offset1:3
    ds_read_b128 v[28:31], v3 offset:0
    ds_read2_b32 v[32:33], v2 offset0:8 offset1:9
    ds_read2_b32 v[34:35], v2 offset0:10 offset1:11
    ds_read_b128 v[36:39], v3 offset:32
    ds_read2_b32 v[40:41], v2 offset0:16 offset1:17
    ds_read2_b32 v[42:43], v2 offset0:18 offset1:19
    ds_read_b128 v[44:47], v3 offset:64
    s_waitcnt lgkmcnt(6)
    v_mfma_f32_32x32x16_bf16 v[8:23], v[24:27], v[28:31], v[8:23]
    ds_read2_b32 v[48:49], v2 offset0:24 offset1:25
    ds_read2_b32 v[50:51], v2 offset0:26 offset1:27
    ds_read_b128 v[52:55], v3 offset:96
    s_waitcnt lgkmcnt(6)
    v_mfma_f32_32x32x16_bf16 v[8:23], v[32:35], v[36:39], v[8:23]
    ds_read2_b32 v[24:25], v2 offset0:32 offset1:33
    ds_read2_b32 v[26:27], v2 offset0:34 offset1:35
    ds_read_b128 v[28:31], v3 offset:144
    s_waitcnt lgkmcnt(6)
    v_mfma_f32_32x32x16_bf16 v[8:23], v[40:43], v[44:47], v[8:23]
    ds_read2_b32 v[32:33], v2 offset0:40 offset1:41
    ds_read2_b32 v[34:35], v2 offset0:42 offset1:43
    ds_read_b128 v[36:39], v3 offset:176
    s_waitcnt lgkmcnt(6)
    v_mfma_f32_32x32x16_bf16 v[8:23], v[48:51], v[52:55], v[8:23]
    ds_read2_b32 v[40:41], v2 offset0:48 offset1:49
    ds_read2_b32 v[42:43], v2 offset0:50 offset1:51
    ds_read_b128 v[44:47], v3 offset:208
    s_waitcnt lgkmcnt(6)
    v_mfma_f32_32x32x16_bf16 v[8:23], v[24:27], v[28:31], v[8:23]
    ds_read_b32 v6, v5
    ds_read2_b32 v[48:49], v2 offset0:56 offset1:57
    ds_read2_b32 v[50:51], v2 offset0:58 offset1:59
    ds_read_b128 v[52:55], v3 offset:240
    s_waitcnt lgkmcnt(7)
    v_mfma_f32_32x32x16_bf16 v[8:23], v[32:35], v[36:39], v[8:23]
    ds_read2_b32 v[24:25], v2 offset0:64 offset1:65
    ds_read2_b32 v[26:27], v2 offset0:66 offset1:67
    ds_read_b128 v[28:31], v3 offset:288
    s_waitcnt lgkmcnt(6)
    v_mfma_f32_32x32x16_bf16 v[8:23], v[40:43], v[44:47], v[8:23]
    ds_read2_b32 v[32:33], v2 offset0:72 offset1:73
    ds_read2_b32 v[34:35], v2 offset0:74 offset1:75
    ds_read_b128 v[36:39], v3 offset:320
    s_waitcnt lgkmcnt(6)
    v_mfma_f32_32x32x16_bf16 v[8:23], v[48:51], v[52:55], v[8:23]
    v_cmp_ge_u32 vcc, s33, v6
    v_readfirstlane_b32 s37, v6
    s_setprio 1
    s_lshl_b32 s42, s34, 2
    s_add_u32 s42, s42, 9
    s_or_b32 s14, s32, s85
    s_cbranch_scc0 K2_CP7
    s_call_b64 s[92:93], K2_POST
K2_CP7:
    s_cbranch_vccnz K2_CK7
    s_call_b64 s[96:97], K2_REDUCE
K2_CK7:
    s_mul_i32 s37, s37, 3
    s_cmp_ge_u32 s42, s37
    s_cbranch_scc1 K2_CL7
    s_setprio 3
K2_CL7:
    ds_read2_b32 v[40:41], v2 offset0:80 offset1:81
    ds_read2_b32 v[42:43], v2 offset0:82 offset1:83
    ds_read_b128 v[44:47], v3 offset:352
    s_waitcnt lgkmcnt(6)
    v_mfma_f32_32x32x16_bf16 v[8:23], v[24:27], v[28:31], v[8:23]
    ds_read2_b32 v[48:49], v2 offset0:88 offset1:89
    ds_read2_b32 v[50:51], v2 offset0:90 offset1:91
    ds_read_b128 v[52:55], v3 offset:384
    s_waitcnt lgkmcnt(6)
    v_mfma_f32_32x32x16_bf16 v[8:23], v[32:35], v[36:39], v[8:23]
    ds_read2_b32 v[24:25], v2 offset0:96 offset1:97
    ds_read2_b32 v[26:27], v2 offset0:98 offset1:99
    ds_read_b128 v[28:31], v3 offset:432
    s_waitcnt lgkmcnt(6)
    v_mfma_f32_32x32x16_bf16 v[8:23], v[40:43], v[44:47], v[8:23]
    ds_read2_b32 v[32:33], v2 offset0:104 offset1:105
    ds_read2_b32 v[34:35], v2 offset0:106 offset1:107
    ds_read_b128 v[36:39], v3 offset:464
    s_waitcnt lgkmcnt(6)
    v_mfma_f32_32x32x16_bf16 v[8:23], v[48:51], v[52:55], v[8:23]
    ds_read2_b32 v[40:41], v2 offset0:112 offset1:113
    ds_read2_b32 v[42:43], v2 offset0:114 offset1:115
    ds_read_b128 v[44:47], v3 offset:496
    s_waitcnt lgkmcnt(6)
    v_mfma_f32_32x32x16_bf16 v[8:23], v[24:27], v[28:31], v[8:23]
    ds_read_b32 v6, v5
    ds_read2_b32 v[48:49], v2 offset0:120 offset1:121
    ds_read2_b32 v[50:51], v2 offset0:122 offset1:123
    ds_read_b128 v[52:55], v3 offset:528
    s_waitcnt lgkmcnt(7)
    v_mfma_f32_32x32x16_bf16 v[8:23], v[32:35], v[36:39], v[8:23]
    ds_read2_b32 v[24:25], v2 offset0:128 offset1:129
    ds_read2_b32 v[26:27], v2 offset0:130 offset1:131
    ds_read_b128 v[28:31], v3 offset:576
    s_waitcnt lgkmcnt(6)
    v_mfma_f32_32x32x16_bf16 v[8:23], v[40:43], v[44:47], v[8:23]
    ds_read2_b32 v[32:33], v2 offset0:136 offset1:137
    ds_read2_b32 v[34:35], v2 offset0:138 offset1:139
    ds_read_b128 v[36:39], v3 offset:608
    s_waitcnt lgkmcnt(6)
    v_mfma_f32_32x32x16_bf16 v[8:23], v[48:51], v[52:55], v[8:23]
    v_cmp_ge_u32 vcc, s33, v6
    v_readfirstlane_b32 s37, v6
    s_setprio 1
    s_lshl_b32 s42, s34, 2
    s_add_u32 s42, s42, 10
    s_or_b32 s14, s32, s85
    s_cbranch_scc0 K2_CP15
    s_call_b64 s[92:93], K2_POST
K2_CP15:
    s_cbranch_vccnz K2_CK15
    s_call_b64 s[96:97], K2_REDUCE
K2_CK15:
    s_mul_i32 s37, s37, 3
    s_cmp_ge_u32 s42, s37
    s_cbranch_scc1 K2_CL15
    s_setprio 3
K2_CL15:
    ds_read2_b32 v[40:41], v2 offset0:144 offset1:145
    ds_read2_b32 v[42:43], v2 offset0:146 offset1:147
    ds_read_b128 v[44:47], v3 offset:640
    s_waitcnt lgkmcnt(6)
    v_mfma_f32_32x32x16_bf16 v[8:23], v[24:27], v[28:31], v[8:23]
    ds_read2_b32 v[48:49], v2 offset0:152 offset1:153
    ds_read2_b32 v[50:51], v2 offset0:154 offset1:155
    ds_read_b128 v[52:55], v3 offset:672
    s_waitcnt lgkmcnt(6)
    v_mfma_f32_32x32x16_bf16 v[8:23], v[32:35], v[36:39], v[8:23]
    ds_read2_b32 v[24:25], v2 offset0:160 offset1:161
    ds_read2_b32 v[26:27], v2 offset0:162 offset1:163
    ds_read_b128 v[28:31], v3 offset:720
    s_waitcnt lgkmcnt(6)
    v_mfma_f32_32x32x16_bf16 v[8:23], v[40:43], v[44:47], v[8:23]
    ds_read2_b32 v[32:33], v2 offset0:168 offset1:169
    ds_read2_b32 v[34:35], v2 offset0:170 offset1:171
    ds_read_b128 v[36:39], v3 offset:752
    s_waitcnt lgkmcnt(6)
    v_mfma_f32_32x32x16_bf16 v[8:23], v[48:51], v[52:55], v[8:23]
    ds_read2_b32 v[40:41], v2 offset0:176 offset1:177
    ds_read2_b32 v[42:43], v2 offset0:178 offset1:179
    ds_read_b128 v[44:47], v3 offset:784
    s_waitcnt lgkmcnt(6)
    v_mfma_f32_32x32x16_bf16 v[8:23], v[24:27], v[28:31], v[8:23]
    ds_read_b32 v6, v5
    ds_read2_b32 v[48:49], v2 offset0:184 offset1:185
    ds_read2_b32 v[50:51], v2 offset0:186 offset1:187
    ds_read_b128 v[52:55], v3 offset:816
    s_waitcnt lgkmcnt(7)
    v_mfma_f32_32x32x16_bf16 v[8:23], v[32:35], v[36:39], v[8:23]
    ds_read2_b32 v[24:25], v2 offset0:192 offset1:193
    ds_read2_b32 v[26:27], v2 offset0:194 offset1:195
    ds_read_b128 v[28:31], v3 offset:864
    s_waitcnt lgkmcnt(6)
    v_mfma_f32_32x32x16_bf16 v[8:23], v[40:43], v[44:47], v[8:23]
    ds_read2_b32 v[32:33], v2 offset0:200 offset1:201
    ds_read2_b32 v[34:35], v2 offset0:202 offset1:203
    ds_read_b128 v[36:39], v3 offset:896
    s_waitcnt lgkmcnt(6)
    v_mfma_f32_32x32x16_bf16 v[8:23], v[48:51], v[52:55], v[8:23]
    v_cmp_ge_u32 vcc, s33, v6
    v_readfirstlane_b32 s37, v6
    s_setprio 1
    s_lshl_b32 s42, s34, 2
    s_add_u32 s42, s42, 11
    s_or_b32 s14, s32, s85
    s_cbranch_scc0 K2_CP23
    s_call_b64 s[92:93], K2_POST
K2_CP23:
    s_cbranch_vccnz K2_CK23
    s_call_b64 s[96:97], K2_REDUCE
K2_CK23:
    s_mul_i32 s37, s37, 3
    s_cmp_ge_u32 s42, s37
    s_cbranch_scc1 K2_CL23
    s_setprio 3
K2_CL23:
    ds_read2_b32 v[40:41], v2 offset0:208 offset1:209
    ds_read2_b32 v[42:43], v2 offset0:210 offset1:211
    ds_read_b128 v[44:47], v3 offset:928
    s_waitcnt lgkmcnt(6)
    v_mfma_f32_32x32x16_bf16 v[8:23], v[24:27], v[28:31], v[8:23]
    ds_read2_b32 v[48:49], v2 offset0:216 offset1:217
    ds_read2_b32 v[50:51], v2 offset0:218 offset1:219
    ds_read_b128 v[52:55], v3 offset:960
    s_waitcnt lgkmcnt(6)
    v_mfma_f32_32x32x16_bf16 v[8:23], v[32:35], v[36:39], v[8:23]
    ds_read2_b32 v[24:25], v2 offset0:224 offset1:225
    ds_read2_b32 v[26:27], v2 offset0:226 offset1:227
    ds_read_b128 v[28:31], v3 offset:1008
    s_waitcnt lgkmcnt(6)
    v_mfma_f32_32x32x16_bf16 v[8:23], v[40:43], v[44:47], v[8:23]
    ds_read2_b32 v[32:33], v2 offset0:232 offset1:233
    ds_read2_b32 v[34:35], v2 offset0:234 offset1:235
    ds_read_b128 v[36:39], v3 offset:1040
    s_waitcnt lgkmcnt(6)
    v_mfma_f32_32x32x16_bf16 v[8:23], v[48:51], v[52:55], v[8:23]
    ds_read2_b32 v[40:41], v2 offset0:240 offset1:241
    ds_read2_b32 v[42:43], v2 offset0:242 offset1:243
    ds_read_b128 v[44:47], v3 offset:1072
    s_waitcnt lgkmcnt(6)
    v_mfma_f32_32x32x16_bf16 v[8:23], v[24:27], v[28:31], v[8:23]
    ds_read_b32 v6, v5
    ds_read2_b32 v[48:49], v2 offset0:248 offset1:249
    ds_read2_b32 v[50:51], v2 offset0:250 offset1:251
    ds_read_b128 v[52:55], v3 offset:1104
    s_waitcnt lgkmcnt(7)
    v_mfma_f32_32x32x16_bf16 v[8:23], v[32:35], v[36:39], v[8:23]
    s_waitcnt lgkmcnt(3)
    v_mfma_f32_32x32x16_bf16 v[8:23], v[40:43], v[44:47], v[8:23]
    s_waitcnt lgkmcnt(0)
    v_mfma_f32_32x32x16_bf16 v[8:23], v[48:51], v[52:55], v[8:23]
    v_cmp_ge_u32 vcc, s33, v6
    v_readfirstlane_b32 s37, v6
    s_setprio 1
    s_lshl_b32 s42, s34, 2
    s_add_u32 s42, s42, 12
    s_or_b32 s14, s32, s85
    s_cbranch_scc0 K2_CP31
    s_call_b64 s[92:93], K2_POST
K2_CP31:
    s_cbranch_vccnz K2_CK31
    s_call_b64 s[96:97], K2_REDUCE
K2_CK31:
    s_mul_i32 s37, s37, 3
    s_cmp_ge_u32 s42, s37
    s_cbranch_scc1 K2_CL31
    s_setprio 3
K2_CL31:
    v_add_u32 v2, 1024, v2
    v_add_u32 v3, 1152, v3
    s_add_u32 s34, s34, 1
    s_bitcmp1_b32 s34, 0
    s_cbranch_scc1 K2_CONV
    s_cmp_eq_u32 s34, 2
    s_cselect_b32 s14, s31, 1
    s_cmp_eq_u32 s14, 0
    s_cbranch_scc1 K2_CONV
    s_setprio 3
    s_lshl_b32 s14, s28, 7
    s_add_u32 s14, s14, s21
    s_add_u32 s15, s14, 81920
    s_lshl_b32 s37, s4, 11
    s_add_u32 s37, s37, 143360
    v_bfe_u32 v160, v0, 1, 4
    v_lshlrev_b32 v160, 7, v160
    v_lshrrev_b32 v161, 5, v0
    v_lshl_add_u32 v160, v161, 5, v160
    v_and_b32 v161, 1, v0
    v_lshl_add_u32 v160, v161, 4, v160
    v_add_u32 v160, s37, v160
    v_add_u32 v161, s37, v4
    v_lshrrev_b32 v162, 3, v0
    v_mul_u32_u24 v162, 10240, v162
    v_and_b32 v163, 7, v0
    v_lshl_add_u32 v162, v163, 4, v162
    v_cvt_pk_bf16_f32 v56, v8, v9
    v_cvt_pk_bf16_f32 v57, v10, v11
    v_cvt_pk_bf16_f32 v58, v12, v13
    v_cvt_pk_bf16_f32 v59, v14, v15
    v_cvt_pk_bf16_f32 v60, v16, v17
    v_cvt_pk_bf16_f32 v61, v18, v19
    v_cvt_pk_bf16_f32 v62, v20, v21
    v_cvt_pk_bf16_f32 v63, v22, v23
    v_min_u32 v56, -2, v56
    v_min_u32 v57, -2, v57
    v_min_u32 v58, -2, v58
    v_min_u32 v59, -2, v59
    v_min_u32 v60, -2, v60
    v_min_u32 v61, -2, v61
    v_min_u32 v62, -2, v62
    v_min_u32 v63, -2, v63
    ds_write_b128 v160, v[56:59]
    ds_write_b128 v160, v[60:63] offset:64
    ds_read_b128 v[64:67], v161
    ds_read_b128 v[68:71], v161 offset:1024
    s_waitcnt lgkmcnt(0)
    buffer_store_dwordx4 v[64:67], v162, s[44:47], s14 offen sc1
    buffer_store_dwordx4 v[68:71], v162, s[44:47], s15 offen sc1
    v_mov_b64 v[8:9], 0
    v_mov_b64 v[10:11], 0
    v_mov_b64 v[12:13], 0
    v_mov_b64 v[14:15], 0
    v_mov_b64 v[16:17], 0
    v_mov_b64 v[18:19], 0
    v_mov_b64 v[20:21], 0
    v_mov_b64 v[22:23], 0
    v_add_u32 v2, s22, v2
    v_add_u32 v3, s23, v3
    s_mov_b32 s28, s29
    s_cmp_eq_u32 s34, 2
    s_cselect_b32 s14, s31, 0
    s_cmp_eq_u32 s14, 1
    s_cbranch_scc1 K2_CONV
    s_setprio 3
    s_lshl_b32 s14, s4, 2
    s_add_u32 s14, s14, 10336
    v_mov_b32 v160, s14
    v_mov_b32 v161, 1
    ds_write_b32 v160, v161
    s_or_b32 s14, s32, s85
    s_cbranch_scc0 K2_TAIL
    s_call_b64 s[92:93], K2_POST
K2_TAIL:
    s_cmp_ge_u32 s33, 8
    s_cbranch_scc1 K2_H_END
    ds_read_b32 v6, v5
    s_waitcnt lgkmcnt(0)
    v_cmp_ge_u32 vcc, s33, v6
    s_nop 3
    s_cbranch_vccz K2_TAIL_GO
    s_sleep 6
    s_branch K2_TAIL
K2_TAIL_GO:
    s_call_b64 s[96:97], K2_REDUCE
    s_setprio 3
    s_call_b64 s[92:93], K2_POST
    s_branch K2_TAIL
K2_H_END:
    s_branch P3_EPI
K2_POST:
    v_mov_b32 v163, s32
    v_mov_b32 v162, 1
    s_waitcnt vmcnt(0)
    s_cmp_eq_u32 s32, 0
    s_cbranch_scc1 K2_POST_F
    s_mov_b32 s32, 0
    s_mov_b64 exec, 1
    buffer_atomic_add v162, v163, s[44:47], 0 offen sc1
    s_mov_b64 exec, -1
K2_POST_F:
    s_cmp_eq_u32 s85, 0
    s_cbranch_scc1 K2_POST_R
    v_mov_b32 v163, s85
    ds_write_b32 v163, v162
    s_mov_b32 s85, 0
K2_POST_R:
    s_setpc_b64 s[92:93]
K2_REDUCE:
    s_setprio 3
    s_cmp_eq_u32 s32, 0
    s_cbranch_scc1 K2_RED0
    s_call_b64 s[92:93], K2_POST
K2_RED0:
    s_mul_i32 s14, s33, 43
    s_lshr_b32 s14, s14, 7
    s_mul_i32 s14, s14, 3
    s_sub_u32 s14, s33, s14
    s_mul_i32 s35, s14, 24576
    s_add_u32 s35, s35, 10496
    v_add_u32 v160, s35, v4
    s_waitcnt lgkmcnt(0)
    ds_read_b128 v[56:59], v160 offset:0
    ds_read_b128 v[60:63], v160 offset:1024
    ds_read_b128 v[64:67], v160 offset:2048
    ds_read_b128 v[68:71], v160 offset:3072
    ds_read_b128 v[72:75], v160 offset:4096
    ds_read_b128 v[76:79], v160 offset:5120
    ds_read_b128 v[80:83], v160 offset:6144
    ds_read_b128 v[84:87], v160 offset:7168
    ds_read_b128 v[88:91], v160 offset:8192
    ds_read_b128 v[92:95], v160 offset:9216
    ds_read_b128 v[96:99], v160 offset:10240
    ds_read_b128 v[100:103], v160 offset:11264
    s_waitcnt lgkmcnt(6)
    v_pk_add_f32 v[56:57], v[56:57], v[68:69]
    v_pk_add_f32 v[58:59], v[58:59], v[70:71]
    v_pk_add_f32 v[60:61], v[60:61], v[72:73]
    v_pk_add_f32 v[62:63], v[62:63], v[74:75]
    v_pk_add_f32 v[64:65], v[64:65], v[76:77]
    v_pk_add_f32 v[66:67], v[66:67], v[78:79]
    ds_read_b128 v[104:107], v160 offset:12288
    ds_read_b128 v[108:111], v160 offset:13312
    ds_read_b128 v[112:115], v160 offset:14336
    ds_read_b128 v[116:119], v160 offset:15360
    ds_read_b128 v[120:123], v160 offset:16384
    ds_read_b128 v[124:127], v160 offset:17408
    ds_read_b128 v[128:131], v160 offset:18432
    ds_read_b128 v[132:135], v160 offset:19456
    ds_read_b128 v[136:139], v160 offset:20480
    ds_read_b128 v[140:143], v160 offset:21504
    ds_read_b128 v[144:147], v160 offset:22528
    ds_read_b128 v[148:151], v160 offset:23552
    s_waitcnt lgkmcnt(12)
    v_pk_add_f32 v[80:81], v[80:81], v[92:93]
    v_pk_add_f32 v[82:83], v[82:83], v[94:95]
    v_pk_add_f32 v[84:85], v[84:85], v[96:97]
    v_pk_add_f32 v[86:87], v[86:87], v[98:99]
    v_pk_add_f32 v[88:89], v[88:89], v[100:101]
    v_pk_add_f32 v[90:91], v[90:91], v[102:103]
    v_pk_add_f32 v[56:57], v[56:57], v[80:81]
    v_pk_add_f32 v[58:59], v[58:59], v[82:83]
    v_pk_add_f32 v[60:61], v[60:61], v[84:85]
    v_pk_add_f32 v[62:63], v[62:63], v[86:87]
    v_pk_add_f32 v[64:65], v[64:65], v[88:89]
    v_pk_add_f32 v[66:67], v[66:67], v[90:91]
    s_waitcnt lgkmcnt(6)
    v_pk_add_f32 v[104:105], v[104:105], v[116:117]
    v_pk_add_f32 v[106:107], v[106:107], v[118:119]
    v_pk_add_f32 v[108:109], v[108:109], v[120:121]
    v_pk_add_f32 v[110:111], v[110:111], v[122:123]
    v_pk_add_f32 v[112:113], v[112:113], v[124:125]
    v_pk_add_f32 v[114:115], v[114:115], v[126:127]
    s_waitcnt lgkmcnt(0)
    v_pk_add_f32 v[128:129], v[128:129], v[140:141]
    v_pk_add_f32 v[130:131], v[130:131], v[142:143]
    v_pk_add_f32 v[132:133], v[132:133], v[144:145]
    v_pk_add_f32 v[134:135], v[134:135], v[146:147]
    v_pk_add_f32 v[136:137], v[136:137], v[148:149]
    v_pk_add_f32 v[138:139], v[138:139], v[150:151]
    v_pk_add_f32 v[56:57], v[56:57], v[104:105]
    v_pk_add_f32 v[58:59], v[58:59], v[106:107]
    v_pk_add_f32 v[60:61], v[60:61], v[108:109]
    v_pk_add_f32 v[62:63], v[62:63], v[110:111]
    v_pk_add_f32 v[64:65], v[64:65], v[112:113]
    v_pk_add_f32 v[66:67], v[66:67], v[114:115]
    v_pk_add_f32 v[56:57], v[56:57], v[128:129]
    v_pk_add_f32 v[58:59], v[58:59], v[130:131]
    v_pk_add_f32 v[60:61], v[60:61], v[132:133]
    v_pk_add_f32 v[62:63], v[62:63], v[134:135]
    v_pk_add_f32 v[64:65], v[64:65], v[136:137]
    v_pk_add_f32 v[66:67], v[66:67], v[138:139]
K2_RED_NORM:
    v_mov_b32 v68, v64
    v_mov_b32 v69, v64
    s_mov_b32 s14, s87
    s_mul_i32 s15, s33, 10240
    v_permlane32_swap_b32 v68, v69
    s_add_u32 s14, s14, s15
    s_add_u32 s36, s14, 8847360
    v_rcp_f32 v68, v69
    v_pk_mul_f32 v[80:81], v[56:57], 0 op_sel_hi:[1,0]
    v_pk_fma_f32 v[80:81], v[58:59], 0, v[80:81] op_sel_hi:[1,0,1]
    v_pk_fma_f32 v[80:81], v[60:61], 0, v[80:81] op_sel_hi:[1,0,1]
    v_pk_fma_f32 v[80:81], v[62:63], 0, v[80:81] op_sel_hi:[1,0,1]
    v_pk_fma_f32 v[80:81], v[64:65], 0, v[80:81] op_sel_hi:[1,0,1]
    v_pk_fma_f32 v[80:81], v[66:67], 0, v[80:81] op_sel_hi:[1,0,1]
    v_add_f32 v70, v80, v81
    v_add_f32 v70, v70, v69
    v_add_u32 v70, 0xcf800000, v70
    v_cmp_lt_u32 vcc, 0x2d000000, v70
    v_pk_mul_f32 v[56:57], v[56:57], v[68:69] op_sel_hi:[1,0]
    v_pk_mul_f32 v[58:59], v[58:59], v[68:69] op_sel_hi:[1,0]
    v_pk_mul_f32 v[60:61], v[60:61], v[68:69] op_sel_hi:[1,0]
    v_pk_mul_f32 v[62:63], v[62:63], v[68:69] op_sel_hi:[1,0]
    v_pk_mul_f32 v[64:65], v[64:65], v[68:69] op_sel_hi:[1,0]
    v_pk_mul_f32 v[66:67], v[66:67], v[68:69] op_sel_hi:[1,0]
    s_cbranch_vccnz K2_SLOW
K2_RED_OUT:
    v_cvt_pk_bf16_f32 v72, v56, v57
    v_cvt_pk_bf16_f32 v73, v58, v59
    v_cvt_pk_bf16_f32 v74, v60, v61
    v_cvt_pk_bf16_f32 v75, v62, v63
    v_cvt_pk_bf16_f32 v76, v64, v65
    v_cvt_pk_bf16_f32 v77, v66, v67
    v_min_u32 v72, -2, v72
    v_min_u32 v73, -2, v73
    v_min_u32 v74, -2, v74
    v_min_u32 v75, -2, v75
    v_min_u32 v76, -2, v76
    v_min_u32 v77, -2, v77
    s_nop 0
    v_permlane32_swap_b32 v72, v74
    v_permlane32_swap_b32 v73, v75
    s_add_u32 s14, s33, 6
    v_mov_b32 v161, s14
    s_lshl_b32 s14, s4, 2
    s_add_u32 s14, s14, 10272
    v_mov_b32 v162, s14
    ds_write_b32 v162, v161
    s_add_u32 s33, s33, 4
    s_cmp_eq_u32 s33, 7
    s_cselect_b32 s33, 11, s33
    buffer_store_dwordx4 v[72:75], v4, s[44:47], s36 offen sc1
    s_mov_b32 exec_hi, 0
    buffer_store_dwordx2 v[76:77], v1, s[44:47], s36 offen offset:1024 sc1
    s_mov_b64 exec, -1
    s_cmp_eq_u32 s33, 8
    s_cbranch_scc1 K2_RH4
    s_cmp_eq_u32 s33, 9
    s_cbranch_scc1 K2_RH5
    s_cmp_eq_u32 s33, 10
    s_cbranch_scc1 K2_RH6
K2_RRET:
    s_setprio 1
    s_setpc_b64 s[96:97]
K2_RH4:
    s_lshl_b32 s13, s89, 7
    s_add_u32 s13, s13, 11476992
    v_mov_b32 v160, 0
    s_mov_b64 exec, 1
K2_WP:
    buffer_load_dword v161, v160, s[44:47], s13 offen sc1
    s_waitcnt vmcnt(0)
    v_cmp_ne_u32 vcc, 128, v161
    s_nop 3
    s_cbranch_vccz K2_WP_OK
    s_sleep 6
    s_branch K2_WP
K2_WP_OK:
    s_mov_b64 exec, -1
    v_mov_b32 v160, 10368
    v_mov_b32 v161, 1
    ds_write_b32 v160, v161
    s_and_b32 s14, s88, 3
    s_lshl_b32 s14, s14, 14
    s_add_u32 s13, s86, s14
    s_add_u32 s13, s13, 36864
    v_lshlrev_b32 v160, 6, v0
    buffer_load_dword v152, v160, s[44:47], s13 offen sc1
    s_add_u32 s13, s13, 4096
    buffer_load_dword v153, v160, s[44:47], s13 offen sc1
    s_add_u32 s13, s13, 4096
    buffer_load_dword v154, v160, s[44:47], s13 offen sc1
    s_add_u32 s13, s13, 4096
    buffer_load_dword v155, v160, s[44:47], s13 offen sc1
    s_add_u32 s13, s13, 4096
    s_branch K2_RRET
K2_RH5:
K2_RHW0:
    ds_read_b32 v160, v5 offset:128
    s_waitcnt lgkmcnt(0)
    v_cmp_gt_u32 vcc, 1, v160
    s_nop 3
    s_and_b32 s14, vcc_lo, 1
    s_cbranch_scc0 K2_RHW0_OK
    s_sleep 1
    s_branch K2_RHW0
K2_RHW0_OK:
    s_mov_b32 m0, 59648
    s_add_u32 s14, s86, 0
    buffer_load_dwordx4 v4, s[44:47], s14 offen sc1 lds
    s_mov_b32 m0, 60672
    s_add_u32 s14, s86, 1024
    buffer_load_dwordx4 v4, s[44:47], s14 offen sc1 lds
    s_mov_b32 m0, 61696
    s_add_u32 s14, s86, 2048
    buffer_load_dwordx4 v4, s[44:47], s14 offen sc1 lds
    s_mov_b32 m0, 62720
    s_add_u32 s14, s86, 3072
    buffer_load_dwordx4 v4, s[44:47], s14 offen sc1 lds
    s_mov_b32 m0, 63744
    s_add_u32 s14, s86, 4096
    buffer_load_dwordx4 v4, s[44:47], s14 offen sc1 lds
    s_mov_b32 m0, 64768
    s_add_u32 s14, s86, 5120
    buffer_load_dwordx4 v4, s[44:47], s14 offen sc1 lds
    s_mov_b32 m0, 65792
    s_add_u32 s14, s86, 6144
    buffer_load_dwordx4 v4, s[44:47], s14 offen sc1 lds
    s_mov_b32 m0, 66816
    s_add_u32 s14, s86, 7168
    buffer_load_dwordx4 v4, s[44:47], s14 offen sc1 lds
    s_mov_b32 m0, 67840
    s_add_u32 s14, s86, 8192
    buffer_load_dwordx4 v4, s[44:47], s14 offen sc1 lds
    s_mov_b32 m0, 68864
    s_add_u32 s14, s86, 9216
    buffer_load_dwordx4 v4, s[44:47], s14 offen sc1 lds
    s_mov_b32 m0, 69888
    s_add_u32 s14, s86, 10240
    buffer_load_dwordx4 v4, s[44:47], s14 offen sc1 lds
    s_mov_b32 m0, 70912
    s_add_u32 s14, s86, 11264
    buffer_load_dwordx4 v4, s[44:47], s14 offen sc1 lds
    s_mov_b32 m0, 71936
    s_add_u32 s14, s86, 12288
    buffer_load_dwordx4 v4, s[44:47], s14 offen sc1 lds
    s_mov_b32 m0, 72960
    s_add_u32 s14, s86, 13312
    buffer_load_dwordx4 v4, s[44:47], s14 offen sc1 lds
    s_mov_b32 m0, 73984
    s_add_u32 s14, s86, 14336
    buffer_load_dwordx4 v4, s[44:47], s14 offen sc1 lds
    s_mov_b32 m0, 75008
    s_add_u32 s14, s86, 15360
    buffer_load_dwordx4 v4, s[44:47], s14 offen sc1 lds
    s_mov_b32 m0, 76032
    s_add_u32 s14, s86, 16384
    buffer_load_dwordx4 v4, s[44:47], s14 offen sc1 lds
    s_mov_b32 m0, 77056
    s_add_u32 s14, s86, 17408
    buffer_load_dwordx4 v4, s[44:47], s14 offen sc1 lds
    s_mov_b32 m0, 78080
    s_add_u32 s14, s86, 18432
    buffer_load_dwordx4 v4, s[44:47], s14 offen sc1 lds
    s_mov_b32 m0, 79104
    s_add_u32 s14, s86, 19456
    buffer_load_dwordx4 v4, s[44:47], s14 offen sc1 lds
    s_mov_b32 m0, 80128
    s_add_u32 s14, s86, 20480
    buffer_load_dwordx4 v4, s[44:47], s14 offen sc1 lds
    s_mov_b32 m0, 81152
    s_add_u32 s14, s86, 21504
    buffer_load_dwordx4 v4, s[44:47], s14 offen sc1 lds
    s_mov_b32 m0, 82176
    s_add_u32 s14, s86, 22528
    buffer_load_dwordx4 v4, s[44:47], s14 offen sc1 lds
    s_mov_b32 m0, 83200
    s_add_u32 s14, s86, 23552
    buffer_load_dwordx4 v4, s[44:47], s14 offen sc1 lds
    s_mov_b32 m0, 151552
    s_add_u32 s14, s86, 24576
    buffer_load_dwordx4 v4, s[44:47], s14 offen sc1 lds
    s_mov_b32 m0, 152576
    s_add_u32 s14, s86, 25600
    buffer_load_dwordx4 v4, s[44:47], s14 offen sc1 lds
    s_mov_b32 m0, 153600
    s_add_u32 s14, s86, 26624
    buffer_load_dwordx4 v4, s[44:47], s14 offen sc1 lds
    s_mov_b32 m0, 154624
    s_add_u32 s14, s86, 27648
    buffer_load_dwordx4 v4, s[44:47], s14 offen sc1 lds
    s_mov_b32 m0, 155648
    s_add_u32 s14, s86, 28672
    buffer_load_dwordx4 v4, s[44:47], s14 offen sc1 lds
    s_mov_b32 m0, 156672
    s_add_u32 s14, s86, 29696
    buffer_load_dwordx4 v4, s[44:47], s14 offen sc1 lds
    s_mov_b32 m0, 157696
    s_add_u32 s14, s86, 30720
    buffer_load_dwordx4 v4, s[44:47], s14 offen sc1 lds
    s_mov_b32 m0, 158720
    s_add_u32 s14, s86, 31744
    buffer_load_dwordx4 v4, s[44:47], s14 offen sc1 lds
    s_mov_b32 m0, 159744
    s_add_u32 s14, s86, 32768
    buffer_load_dwordx4 v4, s[44:47], s14 offen sc1 lds
    s_mov_b32 m0, 160768
    s_add_u32 s14, s86, 33792
    buffer_load_dwordx4 v4, s[44:47], s14 offen sc1 lds
    s_mov_b32 m0, 161792
    s_add_u32 s14, s86, 34816
    buffer_load_dwordx4 v4, s[44:47], s14 offen sc1 lds
    s_mov_b32 m0, 162816
    s_add_u32 s14, s86, 35840
    buffer_load_dwordx4 v4, s[44:47], s14 offen sc1 lds
    s_mov_b32 s85, 10304
    s_branch K2_RRET
K2_RH6:
K2_RHW1:
    ds_read_b32 v160, v5 offset:128
    s_waitcnt lgkmcnt(0)
    v_cmp_gt_u32 vcc, 1, v160
    s_nop 3
    s_and_b32 s14, vcc_lo, 1
    s_cbranch_scc0 K2_RHW1_OK
    s_sleep 1
    s_branch K2_RHW1
K2_RHW1_OK:
    s_mov_b32 m0, 10496
    s_add_u32 s14, s86, 36864
    buffer_load_dwordx4 v4, s[44:47], s14 offen sc1 lds
    s_mov_b32 m0, 11520
    s_add_u32 s14, s86, 37888
    buffer_load_dwordx4 v4, s[44:47], s14 offen sc1 lds
    s_mov_b32 m0, 12544
    s_add_u32 s14, s86, 38912
    buffer_load_dwordx4 v4, s[44:47], s14 offen sc1 lds
    s_mov_b32 m0, 13568
    s_add_u32 s14, s86, 39936
    buffer_load_dwordx4 v4, s[44:47], s14 offen sc1 lds
    s_mov_b32 m0, 14592
    s_add_u32 s14, s86, 40960
    buffer_load_dwordx4 v4, s[44:47], s14 offen sc1 lds
    s_mov_b32 m0, 15616
    s_add_u32 s14, s86, 41984
    buffer_load_dwordx4 v4, s[44:47], s14 offen sc1 lds
    s_mov_b32 m0, 16640
    s_add_u32 s14, s86, 43008
    buffer_load_dwordx4 v4, s[44:47], s14 offen sc1 lds
    s_mov_b32 m0, 17664
    s_add_u32 s14, s86, 44032
    buffer_load_dwordx4 v4, s[44:47], s14 offen sc1 lds
    s_mov_b32 m0, 18688
    s_add_u32 s14, s86, 45056
    buffer_load_dwordx4 v4, s[44:47], s14 offen sc1 lds
    s_mov_b32 m0, 19712
    s_add_u32 s14, s86, 46080
    buffer_load_dwordx4 v4, s[44:47], s14 offen sc1 lds
    s_mov_b32 m0, 20736
    s_add_u32 s14, s86, 47104
    buffer_load_dwordx4 v4, s[44:47], s14 offen sc1 lds
    s_mov_b32 m0, 21760
    s_add_u32 s14, s86, 48128
    buffer_load_dwordx4 v4, s[44:47], s14 offen sc1 lds
    s_mov_b32 m0, 22784
    s_add_u32 s14, s86, 49152
    buffer_load_dwordx4 v4, s[44:47], s14 offen sc1 lds
    s_mov_b32 m0, 23808
    s_add_u32 s14, s86, 50176
    buffer_load_dwordx4 v4, s[44:47], s14 offen sc1 lds
    s_mov_b32 m0, 24832
    s_add_u32 s14, s86, 51200
    buffer_load_dwordx4 v4, s[44:47], s14 offen sc1 lds
    s_mov_b32 m0, 25856
    s_add_u32 s14, s86, 52224
    buffer_load_dwordx4 v4, s[44:47], s14 offen sc1 lds
    s_mov_b32 m0, 26880
    s_add_u32 s14, s86, 53248
    buffer_load_dwordx4 v4, s[44:47], s14 offen sc1 lds
    s_mov_b32 m0, 27904
    s_add_u32 s14, s86, 54272
    buffer_load_dwordx4 v4, s[44:47], s14 offen sc1 lds
    s_mov_b32 m0, 28928
    s_add_u32 s14, s86, 55296
    buffer_load_dwordx4 v4, s[44:47], s14 offen sc1 lds
    s_mov_b32 m0, 29952
    s_add_u32 s14, s86, 56320
    buffer_load_dwordx4 v4, s[44:47], s14 offen sc1 lds
    s_mov_b32 m0, 30976
    s_add_u32 s14, s86, 57344
    buffer_load_dwordx4 v4, s[44:47], s14 offen sc1 lds
    s_mov_b32 m0, 32000
    s_add_u32 s14, s86, 58368
    buffer_load_dwordx4 v4, s[44:47], s14 offen sc1 lds
    s_mov_b32 m0, 33024
    s_add_u32 s14, s86, 59392
    buffer_load_dwordx4 v4, s[44:47], s14 offen sc1 lds
    s_mov_b32 m0, 34048
    s_add_u32 s14, s86, 60416
    buffer_load_dwordx4 v4, s[44:47], s14 offen sc1 lds
    s_mov_b32 s85, 10308
    s_branch K2_RRET
K2_SLOW:
    v_and_b32 v131, 31, v0
    v_lshrrev_b32 v132, 5, v0
    v_lshlrev_b32 v130, 3, v131
    v_lshl_add_u32 v130, v132, 2, v130
    s_mul_i32 s14, s33, 1280
    v_add_u32 v129, s14, v4
    v_add_u32 v130, s14, v130
    ds_read_b128 v[112:115], v129 offset:0
    ds_read_b32 v116, v130 offset:1024
    s_waitcnt lgkmcnt(0)
    v_mov_b32 v117, 0
    v_mov_b32 v109, 0
    v_mov_b32 v128, 0xff800000
    v_mov_b32 v133, 0xdddddddd
    v_cmp_gt_u32 s[94:95], 20, v131
    v_mad_u32_u24 v132, v132, 20, v131
    v_lshlrev_b32 v132, 4, v132
    v_mov_b32 v120, 0x3f803f80
    v_mov_b32 v121, 0x3f803f80
    v_mov_b32 v122, 0x3f803f80
    v_mov_b32 v123, 0x3f803f80
    v_mov_b32 v124, 0x3f803f80
    v_mov_b32 v125, 0x3f803f80
    v_mov_b32 v126, 0x3f803f80
    v_mov_b32 v127, 0x3f803f80
    v_mov_b32 v56, 0
    v_mov_b32 v57, 0
    v_mov_b32 v58, 0
    v_mov_b32 v59, 0
    v_mov_b32 v60, 0
    v_mov_b32 v61, 0
    v_mov_b32 v62, 0
    v_mov_b32 v63, 0
    v_mov_b32 v64, 0
    v_mov_b32 v65, 0
    v_mov_b32 v66, 0
    v_mov_b32 v67, 0
    v_mov_b32 v68, 0
    v_mov_b32 v69, 0
    v_mov_b32 v70, 0
    v_mov_b32 v71, 0
    s_mov_b32 s92, 0
K2_SLOW_P0:
    s_lshl_b32 s14, s92, 10
    s_add_u32 s14, s14, 2621440
    buffer_load_dwordx4 v[104:107], v4, s[44:47], s14 offen
    s_lshr_b32 s14, s92, 2
    s_lshl_b32 s14, s14, 10
    s_and_b32 s15, s92, 3
    s_lshl_b32 s15, s15, 2
    s_add_u32 s14, s14, s15
    s_add_u32 s14, s14, 2686976
    buffer_load_dword v108, v4, s[44:47], s14 offen
    s_waitcnt vmcnt(0)
    v_mfma_f32_32x32x16_bf16 v[88:103], v[104:107], v[112:115], 0
    v_mfma_f32_32x32x8_bf16 v[88:103], v[108:109], v[116:117], v[88:103]
    s_nop 15
    v_max3_f32 v128, v128, v88, v89
    v_max3_f32 v128, v128, v90, v91
    v_max3_f32 v128, v128, v92, v93
    v_max3_f32 v128, v128, v94, v95
    v_max3_f32 v128, v128, v96, v97
    v_max3_f32 v128, v128, v98, v99
    v_max3_f32 v128, v128, v100, v101
    v_max3_f32 v128, v128, v102, v103
    s_add_u32 s92, s92, 1
    s_cmp_lt_u32 s92, 64
    s_cbranch_scc1 K2_SLOW_P0
    v_mov_b32 v129, v128
    s_nop 1
    v_permlane32_swap_b32 v129, v128
    s_nop 1
    v_max_f32 v128, v128, v129
    s_mov_b32 s92, 0
K2_SLOW_P1:
    s_lshl_b32 s14, s92, 10
    s_add_u32 s14, s14, 2621440
    buffer_load_dwordx4 v[104:107], v4, s[44:47], s14 offen
    s_lshr_b32 s14, s92, 2
    s_lshl_b32 s14, s14, 10
    s_and_b32 s15, s92, 3
    s_lshl_b32 s15, s15, 2
    s_add_u32 s14, s14, s15
    s_add_u32 s14, s14, 2686976
    buffer_load_dword v108, v4, s[44:47], s14 offen
    s_mul_i32 s14, s92, 1280
    s_add_u32 s14, s14, 2703360
    s_mov_b64 exec, s[94:95]
    buffer_load_dwordx4 v[120:123], v132, s[44:47], s14 offen
    buffer_load_dwordx4 v[124:127], v132, s[44:47], s14 offen offset:640
    s_mov_b64 exec, -1
    s_waitcnt vmcnt(0)
    v_mfma_f32_32x32x16_bf16 v[88:103], v[104:107], v[112:115], 0
    v_mfma_f32_32x32x8_bf16 v[88:103], v[108:109], v[116:117], v[88:103]
    s_nop 15
    v_sub_f32 v88, v88, v128
    v_sub_f32 v89, v89, v128
    v_sub_f32 v90, v90, v128
    v_sub_f32 v91, v91, v128
    v_sub_f32 v92, v92, v128
    v_sub_f32 v93, v93, v128
    v_sub_f32 v94, v94, v128
    v_sub_f32 v95, v95, v128
    v_sub_f32 v96, v96, v128
    v_sub_f32 v97, v97, v128
    v_sub_f32 v98, v98, v128
    v_sub_f32 v99, v99, v128
    v_sub_f32 v100, v100, v128
    v_sub_f32 v101, v101, v128
    v_sub_f32 v102, v102, v128
    v_sub_f32 v103, v103, v128
    v_exp_f32 v88, v88
    v_exp_f32 v89, v89
    v_exp_f32 v90, v90
    v_exp_f32 v91, v91
    v_exp_f32 v92, v92
    v_exp_f32 v93, v93
    v_exp_f32 v94, v94
    v_exp_f32 v95, v95
    v_exp_f32 v96, v96
    v_exp_f32 v97, v97
    v_exp_f32 v98, v98
    v_exp_f32 v99, v99
    v_exp_f32 v100, v100
    v_exp_f32 v101, v101
    v_exp_f32 v102, v102
    v_exp_f32 v103, v103
    s_nop 1
    v_smfmac_f32_32x32x32_bf16 v[56:71], v[120:123], v[88:95], v133
    v_smfmac_f32_32x32x32_bf16 v[56:71], v[124:127], v[96:103], v133
    s_nop 15
    s_add_u32 s92, s92, 1
    s_cmp_lt_u32 s92, 64
    s_cbranch_scc1 K2_SLOW_P1
    v_rcp_f32 v68, v68
    s_nop 0
    v_pk_mul_f32 v[56:57], v[56:57], v[68:69] op_sel_hi:[1,0]
    v_pk_mul_f32 v[58:59], v[58:59], v[68:69] op_sel_hi:[1,0]
    v_pk_mul_f32 v[60:61], v[60:61], v[68:69] op_sel_hi:[1,0]
    v_pk_mul_f32 v[62:63], v[62:63], v[68:69] op_sel_hi:[1,0]
    v_pk_mul_f32 v[64:65], v[64:65], v[68:69] op_sel_hi:[1,0]
    v_pk_mul_f32 v[66:67], v[66:67], v[68:69] op_sel_hi:[1,0]
    s_branch K2_RED_OUT
P3_ATT:
    s_cmp_eq_u32 s3, 7
    s_cbranch_scc0 P3_A0
    s_setprio 3
    v_mbcnt_lo_u32_b32 v0, -1, 0
    v_mbcnt_hi_u32_b32 v0, -1, v0
    v_lshlrev_b32 v4, 4, v0
    v_bfe_u32 v162, v0, 4, 1
    v_lshlrev_b32 v1, 7, v162
    v_and_b32 v162, 7, v0
    v_lshl_add_u32 v1, v162, 4, v1
    v_lshlrev_b32 v5, 2, v162
    v_add_u32 v5, 10240, v5
    v_bfe_u32 v162, v0, 3, 1
    v_lshl_add_u32 v1, v162, 3, v1
    s_mov_b32 s4, 3
    s_mov_b32 s33, 7
    s_mov_b32 s32, 0
    s_mov_b32 s85, 0
    s_mov_b32 s87, s59
    s_and_b32 s88, s2, 7
    s_lshl_b32 s88, s88, 2
    s_lshr_b32 s14, s2, 6
    s_add_u32 s88, s88, s14
P3_R7:
    ds_read_b32 v6, v5 offset:0
    s_waitcnt lgkmcnt(0)
    v_cmp_gt_u32 vcc, 8, v6
    s_nop 3
    s_and_b32 s14, vcc_lo, 255
    s_cbranch_scc1 P3_R7
P3_R7_OK:
    s_call_b64 s[96:97], K2_REDUCE
    s_setprio 3
P3_A0:
    s_setprio 0
    v_mbcnt_lo_u32_b32 v2, -1, 0
    v_mbcnt_hi_u32_b32 v2, -1, v2
    s_and_b32 s4, s2, 7
    s_lshl_b32 s4, s4, 2
    s_lshr_b32 s6, s2, 6
    s_add_u32 s4, s4, s6
    s_bfe_u32 s5, s2, 0x30003
    s_lshr_b32 s9, s3, 2
    s_sub_u32 s7, s3, s9
    s_and_b32 s7, s7, 3
    v_lshlrev_b32 v3, 4, v2
    v_and_b32 v19, 7, v2
    v_lshlrev_b32 v19, 2, v19
    v_add_u32 v19, 10240, v19
    s_mul_i32 s8, s5, 102400
    s_add_u32 s8, s8, 5406720
    v_bfe_u32 v4, v2, 3, 1
    v_mul_u32_u24 v4, 10240, v4
    v_lshrrev_b32 v5, 4, v2
    v_lshl_add_u32 v4, v5, 7, v4
    v_and_b32 v6, 7, v2
    v_lshl_add_u32 v4, v6, 4, v4
    s_lshl_b32 s6, s4, 2
    s_add_u32 s6, s6, s7
    s_mul_i32 s10, s6, 20480
    s_mul_i32 s14, s9, 5120
    s_add_u32 s10, s10, s14
    s_add_u32 s10, s10, 8847360
    s_add_u32 s11, s10, 4096
    s_lshl_b32 s13, s6, 7
    s_add_u32 s13, s13, 11489280
    v_mov_b32 v15, 1
    s_cmp_eq_u32 s7, 3
    s_cbranch_scc1 P3_X1
    buffer_load_dwordx4 v[20:23], v4, s[44:47], s10 offen offset:0 sc1
    buffer_load_dwordx4 v[24:27], v4, s[44:47], s10 offen offset:512 sc1
    buffer_load_dwordx4 v[28:31], v4, s[44:47], s10 offen offset:1024 sc1
    buffer_load_dwordx4 v[32:35], v4, s[44:47], s10 offen offset:1536 sc1
    buffer_load_dwordx4 v[36:39], v4, s[44:47], s10 offen offset:2048 sc1
    buffer_load_dwordx4 v[40:43], v4, s[44:47], s10 offen offset:2560 sc1
    buffer_load_dwordx4 v[44:47], v4, s[44:47], s10 offen offset:3072 sc1
    buffer_load_dwordx4 v[48:51], v4, s[44:47], s10 offen offset:3584 sc1
    buffer_load_dwordx4 v[52:55], v4, s[44:47], s11 offen offset:0 sc1
    buffer_load_dwordx4 v[56:59], v4, s[44:47], s11 offen offset:512 sc1
    s_branch P3_X1b
P3_X1:
P3_X1b:
    s_mul_i32 s14, s7, 2560
    s_add_u32 s14, s14, 0
    v_and_b32 v8, 15, v2
    v_mul_u32_u24 v8, 160, v8
    v_mad_u32_u24 v8, v5, 40, v8
    v_add_u32 v8, s14, v8
    v_add_u32 v9, s14, v3
    s_mul_i32 s14, s7, 5120
    s_add_u32 s14, s14, 84224
    v_add_u32 v18, s14, v3
    s_lshl_b32 s15, s6, 4
    s_mul_i32 s18, s5, 160
    s_add_u32 s18, s18, 1280
    v_add_u32 v6, 65536, v3
    v_add_u32 v7, 131072, v3
    s_mov_b32 s48, s38
    s_and_b32 s49, s39, 0xffff
    s_mov_b32 s50, 5242880
    s_mov_b32 s51, 0x20000
    v_mov_b64 v[60:61], 0
    v_mov_b64 v[62:63], 0
    v_mov_b64 v[64:65], 0
    v_mov_b64 v[66:67], 0
    v_mov_b64 v[68:69], 0
    v_mov_b64 v[70:71], 0
    v_mov_b64 v[72:73], 0
    v_mov_b64 v[74:75], 0
    v_mov_b64 v[76:77], 0
    v_mov_b64 v[78:79], 0
    v_add_u32 v14, 0, v2
    v_mul_u32_u24 v10, 6554, v14
    v_lshrrev_b32 v10, 16, v10
    v_mul_u32_u24 v13, 10, v10
    v_sub_u32 v13, v14, v13
    v_lshl_add_u32 v13, v13, 4, s18
    v_add_u32 v10, s15, v10
    v_mul_u32_u24 v10, 2560, v10
    v_add_u32 v10, v10, v13
    v_add_u32 v14, 64, v2
    v_mul_u32_u24 v11, 6554, v14
    v_lshrrev_b32 v11, 16, v11
    v_mul_u32_u24 v13, 10, v11
    v_sub_u32 v13, v14, v13
    v_lshl_add_u32 v13, v13, 4, s18
    v_add_u32 v11, s15, v11
    v_mul_u32_u24 v11, 2560, v11
    v_add_u32 v11, v11, v13
    v_add_u32 v14, 128, v2
    v_mul_u32_u24 v12, 6554, v14
    v_lshrrev_b32 v12, 16, v12
    v_mul_u32_u24 v13, 10, v12
    v_sub_u32 v13, v14, v13
    v_lshl_add_u32 v13, v13, 4, s18
    v_add_u32 v12, s15, v12
    v_mul_u32_u24 v12, 2560, v12
    v_add_u32 v12, v12, v13
    s_cmp_eq_u32 s7, 3
    s_cbranch_scc0 P3_SC
    s_cmp_eq_u32 s3, 3
    s_cbranch_scc0 P3_S3
P3_WP2b:
    ds_read_b32 v16, v19 offset:128
    s_waitcnt lgkmcnt(0)
    v_cmp_gt_u32 vcc, 1, v16
    s_nop 3
    s_and_b32 s14, vcc_lo, 1
    s_cbranch_scc0 P3_WP2b_OK
    s_sleep 1
    s_branch P3_WP2b
P3_WP2b_OK:
P3_FD0b:
    ds_read_b32 v16, v19 offset:32
    s_waitcnt lgkmcnt(0)
    v_cmp_gt_u32 vcc, 10, v16
    s_nop 3
    s_and_b32 s14, vcc_lo, 15
    s_cbranch_scc1 P3_FD0b
P3_FD0b_OK:
    s_mul_i32 s15, 2, 7168
    s_add_u32 s8, s8, s15
    s_add_u32 s15, s15, 35072
    s_add_u32 m0, s15, 0
    s_add_u32 s14, s8, 80896
    buffer_load_dwordx4 v3, s[44:47], s14 offen sc1 lds
    s_add_u32 m0, s15, 1024
    s_add_u32 s14, s8, 81920
    buffer_load_dwordx4 v3, s[44:47], s14 offen sc1 lds
    s_add_u32 m0, s15, 2048
    s_add_u32 s14, s8, 82944
    buffer_load_dwordx4 v3, s[44:47], s14 offen sc1 lds
    s_add_u32 m0, s15, 3072
    s_add_u32 s14, s8, 83968
    buffer_load_dwordx4 v3, s[44:47], s14 offen sc1 lds
    s_add_u32 m0, s15, 4096
    s_add_u32 s14, s8, 84992
    buffer_load_dwordx4 v3, s[44:47], s14 offen sc1 lds
    s_add_u32 m0, s15, 5120
    s_add_u32 s14, s8, 86016
    buffer_load_dwordx4 v3, s[44:47], s14 offen sc1 lds
    s_add_u32 m0, s15, 6144
    s_add_u32 s14, s8, 87040
    buffer_load_dwordx4 v3, s[44:47], s14 offen sc1 lds
    s_lshl_b32 s14, 2, 2
    s_add_u32 s14, s14, 10316
    v_mov_b32 v14, s14
    s_waitcnt vmcnt(0)
    ds_write_b32 v14, v15
P3_S3:
P3_F7a:
    ds_read_b32 v16, v19 offset:32
    s_waitcnt lgkmcnt(0)
    v_cmp_gt_u32 vcc, 10, v16
    s_nop 3
    s_and_b32 s14, vcc_lo, 15
    s_cbranch_scc0 P3_F7a_OK
    s_sleep 1
    s_branch P3_F7a
P3_F7a_OK:
P3_XD:
    ds_read_b32 v16, v19 offset:64
    s_waitcnt lgkmcnt(0)
    v_cmp_gt_u32 vcc, 1, v16
    s_nop 3
    s_and_b32 s14, vcc_lo, 63
    s_cbranch_scc0 P3_XD_OK
    s_sleep 1
    s_branch P3_XD
P3_XD_OK:
P3_SP:
    buffer_load_dwordx4 v[20:23], v4, s[44:47], s10 offen offset:0 sc1
    buffer_load_dwordx4 v[24:27], v4, s[44:47], s10 offen offset:512 sc1
    buffer_load_dwordx4 v[28:31], v4, s[44:47], s10 offen offset:1024 sc1
    buffer_load_dwordx4 v[32:35], v4, s[44:47], s10 offen offset:1536 sc1
    buffer_load_dwordx4 v[36:39], v4, s[44:47], s10 offen offset:2048 sc1
    buffer_load_dwordx4 v[40:43], v4, s[44:47], s10 offen offset:2560 sc1
    buffer_load_dwordx4 v[44:47], v4, s[44:47], s10 offen offset:3072 sc1
    buffer_load_dwordx4 v[48:51], v4, s[44:47], s10 offen offset:3584 sc1
    buffer_load_dwordx4 v[52:55], v4, s[44:47], s11 offen offset:0 sc1
    buffer_load_dwordx4 v[56:59], v4, s[44:47], s11 offen offset:512 sc1
P3_SC:
    s_waitcnt vmcnt(6)
    v_max3_u32 v14, v20, v21, v22
    v_max3_u32 v14, v14, v23, v24
    v_max3_u32 v14, v14, v25, v26
    v_max3_u32 v14, v14, v27, v28
    v_max3_u32 v14, v14, v29, v30
    v_max3_u32 v14, v14, v31, v32
    v_max3_u32 v14, v14, v33, v34
    s_waitcnt vmcnt(3)
    v_max3_u32 v14, v14, v35, v36
    v_max3_u32 v14, v14, v37, v38
    v_max3_u32 v14, v14, v39, v40
    v_max3_u32 v14, v14, v41, v42
    v_max3_u32 v14, v14, v43, v44
    v_max3_u32 v14, v14, v45, v46
    s_waitcnt vmcnt(0)
    v_max3_u32 v14, v14, v47, v48
    v_max3_u32 v14, v14, v49, v50
    v_max3_u32 v14, v14, v51, v52
    v_max3_u32 v14, v14, v53, v54
    v_max3_u32 v14, v14, v55, v56
    v_max3_u32 v14, v14, v57, v58
    v_max_u32 v14, v14, v59
    v_cmp_eq_u32 vcc, -1, v14
    s_nop 3
    s_cbranch_vccz P3_X2
    s_sleep 2
    s_branch P3_SP
P3_X2:
    s_sub_u32 s14, s3, 5
    s_cmp_lt_u32 s14, 2
    s_cbranch_scc0 P3_X4
P3_WP2a:
    ds_read_b32 v16, v19 offset:128
    s_waitcnt lgkmcnt(0)
    v_cmp_gt_u32 vcc, 1, v16
    s_nop 3
    s_and_b32 s14, vcc_lo, 1
    s_cbranch_scc0 P3_WP2a_OK
    s_sleep 1
    s_branch P3_WP2a
P3_WP2a_OK:
P3_FD0a:
    ds_read_b32 v16, v19 offset:32
    s_waitcnt lgkmcnt(0)
    v_cmp_gt_u32 vcc, 10, v16
    s_nop 3
    s_and_b32 s14, vcc_lo, 15
    s_cbranch_scc1 P3_FD0a
P3_FD0a_OK:
    s_mul_i32 s15, s7, 7168
    s_add_u32 s8, s8, s15
    s_add_u32 s15, s15, 35072
    s_add_u32 m0, s15, 0
    s_add_u32 s14, s8, 80896
    buffer_load_dwordx4 v3, s[44:47], s14 offen sc1 lds
    s_add_u32 m0, s15, 1024
    s_add_u32 s14, s8, 81920
    buffer_load_dwordx4 v3, s[44:47], s14 offen sc1 lds
    s_add_u32 m0, s15, 2048
    s_add_u32 s14, s8, 82944
    buffer_load_dwordx4 v3, s[44:47], s14 offen sc1 lds
    s_add_u32 m0, s15, 3072
    s_add_u32 s14, s8, 83968
    buffer_load_dwordx4 v3, s[44:47], s14 offen sc1 lds
    s_add_u32 m0, s15, 4096
    s_add_u32 s14, s8, 84992
    buffer_load_dwordx4 v3, s[44:47], s14 offen sc1 lds
    s_add_u32 m0, s15, 5120
    s_add_u32 s14, s8, 86016
    buffer_load_dwordx4 v3, s[44:47], s14 offen sc1 lds
    s_add_u32 m0, s15, 6144
    s_add_u32 s14, s8, 87040
    buffer_load_dwordx4 v3, s[44:47], s14 offen sc1 lds
    s_lshl_b32 s14, s7, 2
    s_add_u32 s14, s14, 10316
    v_mov_b32 v14, s14
    s_waitcnt vmcnt(0)
    ds_write_b32 v14, v15
P3_X4:
    s_cmp_eq_u32 s9, 0
    s_cselect_b32 s12, 3, 63
P3_FRW0:
    ds_read_b32 v16, v19 offset:64
    s_waitcnt lgkmcnt(0)
    v_cmp_gt_u32 vcc, 1, v16
    s_nop 3
    s_and_b32 s14, vcc_lo, s12
    s_cbranch_scc0 P3_FRW0_OK
    s_sleep 1
    s_branch P3_FRW0
P3_FRW0_OK:
    s_setprio 2
    s_cmp_eq_u32 s9, 0
    s_cbranch_scc0 P3_HI
    ds_read_b128 v[80:83], v3 offset:59648
    ds_read_b128 v[84:87], v3 offset:60672
    ds_read_b128 v[88:91], v3 offset:61696
    ds_read_b128 v[92:95], v3 offset:62720
    ds_read_b128 v[96:99], v3 offset:63744
    ds_read_b128 v[100:103], v3 offset:64768
    ds_read_b128 v[104:107], v6 offset:256
    ds_read_b128 v[108:111], v6 offset:1280
    ds_read_b128 v[112:115], v6 offset:2304
    ds_read_b128 v[116:119], v6 offset:3328
    ds_read_b128 v[120:123], v6 offset:4352
    ds_read_b128 v[124:127], v6 offset:5376
    ds_read_b128 v[128:131], v6 offset:6400
    ds_read_b128 v[132:135], v6 offset:7424
    ds_read_b128 v[136:139], v6 offset:8448
    s_waitcnt lgkmcnt(10)
    v_mfma_f32_16x16x32_bf16 v[60:63], v[80:83], v[20:23], v[60:63]
    ds_read_b128 v[140:143], v6 offset:9472
    v_mfma_f32_16x16x32_bf16 v[64:67], v[84:87], v[20:23], v[64:67]
    ds_read_b128 v[144:147], v6 offset:10496
    v_mfma_f32_16x16x32_bf16 v[68:71], v[88:91], v[20:23], v[68:71]
    ds_read_b128 v[148:151], v6 offset:11520
    v_mfma_f32_16x16x32_bf16 v[72:75], v[92:95], v[20:23], v[72:75]
    ds_read_b128 v[152:155], v6 offset:12544
    v_mfma_f32_16x16x32_bf16 v[76:79], v[96:99], v[20:23], v[76:79]
    ds_read_b128 v[156:159], v6 offset:13568
    s_waitcnt lgkmcnt(10)
    v_mfma_f32_16x16x32_bf16 v[60:63], v[100:103], v[24:27], v[60:63]
    ds_read_b128 v[80:83], v6 offset:14592
    v_mfma_f32_16x16x32_bf16 v[64:67], v[104:107], v[24:27], v[64:67]
    ds_read_b128 v[84:87], v6 offset:15616
    v_mfma_f32_16x16x32_bf16 v[68:71], v[108:111], v[24:27], v[68:71]
    ds_read_b128 v[88:91], v6 offset:16640
    v_mfma_f32_16x16x32_bf16 v[72:75], v[112:115], v[24:27], v[72:75]
    ds_read_b128 v[92:95], v6 offset:17664
    v_mfma_f32_16x16x32_bf16 v[76:79], v[116:119], v[24:27], v[76:79]
    ds_read_b128 v[96:99], v7 offset:20480
    s_waitcnt lgkmcnt(10)
    v_mfma_f32_16x16x32_bf16 v[60:63], v[120:123], v[28:31], v[60:63]
    ds_read_b128 v[100:103], v7 offset:21504
    v_mfma_f32_16x16x32_bf16 v[64:67], v[124:127], v[28:31], v[64:67]
    ds_read_b128 v[104:107], v7 offset:22528
    v_mfma_f32_16x16x32_bf16 v[68:71], v[128:131], v[28:31], v[68:71]
    ds_read_b128 v[108:111], v7 offset:23552
    v_mfma_f32_16x16x32_bf16 v[72:75], v[132:135], v[28:31], v[72:75]
    ds_read_b128 v[112:115], v7 offset:24576
    v_mfma_f32_16x16x32_bf16 v[76:79], v[136:139], v[28:31], v[76:79]
    ds_read_b128 v[116:119], v7 offset:25600
    s_waitcnt lgkmcnt(10)
    v_mfma_f32_16x16x32_bf16 v[60:63], v[140:143], v[32:35], v[60:63]
    ds_read_b128 v[120:123], v7 offset:26624
    v_mfma_f32_16x16x32_bf16 v[64:67], v[144:147], v[32:35], v[64:67]
    ds_read_b128 v[124:127], v7 offset:27648
    v_mfma_f32_16x16x32_bf16 v[68:71], v[148:151], v[32:35], v[68:71]
    ds_read_b128 v[128:131], v7 offset:28672
    v_mfma_f32_16x16x32_bf16 v[72:75], v[152:155], v[32:35], v[72:75]
    ds_read_b128 v[132:135], v7 offset:29696
    v_mfma_f32_16x16x32_bf16 v[76:79], v[156:159], v[32:35], v[76:79]
    ds_read_b128 v[136:139], v7 offset:30720
    s_waitcnt lgkmcnt(10)
    v_mfma_f32_16x16x32_bf16 v[60:63], v[80:83], v[36:39], v[60:63]
    ds_read_b128 v[140:143], v7 offset:31744
    v_mfma_f32_16x16x32_bf16 v[64:67], v[84:87], v[36:39], v[64:67]
    ds_read_b128 v[144:147], v3 offset:10496
    v_mfma_f32_16x16x32_bf16 v[68:71], v[88:91], v[36:39], v[68:71]
    ds_read_b128 v[148:151], v3 offset:11520
    v_mfma_f32_16x16x32_bf16 v[72:75], v[92:95], v[36:39], v[72:75]
    ds_read_b128 v[152:155], v3 offset:12544
    v_mfma_f32_16x16x32_bf16 v[76:79], v[96:99], v[36:39], v[76:79]
    ds_read_b128 v[156:159], v3 offset:13568
    s_waitcnt lgkmcnt(10)
    v_mfma_f32_16x16x32_bf16 v[60:63], v[100:103], v[40:43], v[60:63]
    ds_read_b128 v[80:83], v3 offset:14592
    v_mfma_f32_16x16x32_bf16 v[64:67], v[104:107], v[40:43], v[64:67]
    ds_read_b128 v[84:87], v3 offset:15616
    v_mfma_f32_16x16x32_bf16 v[68:71], v[108:111], v[40:43], v[68:71]
    ds_read_b128 v[88:91], v3 offset:16640
    v_mfma_f32_16x16x32_bf16 v[72:75], v[112:115], v[40:43], v[72:75]
    ds_read_b128 v[92:95], v3 offset:17664
    v_mfma_f32_16x16x32_bf16 v[76:79], v[116:119], v[40:43], v[76:79]
    ds_read_b128 v[96:99], v3 offset:18688
    s_waitcnt lgkmcnt(10)
    v_mfma_f32_16x16x32_bf16 v[60:63], v[120:123], v[44:47], v[60:63]
    ds_read_b128 v[100:103], v3 offset:19712
    v_mfma_f32_16x16x32_bf16 v[64:67], v[124:127], v[44:47], v[64:67]
    ds_read_b128 v[104:107], v3 offset:20736
    v_mfma_f32_16x16x32_bf16 v[68:71], v[128:131], v[44:47], v[68:71]
    ds_read_b128 v[108:111], v3 offset:21760
    v_mfma_f32_16x16x32_bf16 v[72:75], v[132:135], v[44:47], v[72:75]
    ds_read_b128 v[112:115], v3 offset:22784
    v_mfma_f32_16x16x32_bf16 v[76:79], v[136:139], v[44:47], v[76:79]
    ds_read_b128 v[116:119], v3 offset:23808
    s_waitcnt lgkmcnt(10)
    v_mfma_f32_16x16x32_bf16 v[60:63], v[140:143], v[48:51], v[60:63]
    v_mfma_f32_16x16x32_bf16 v[64:67], v[144:147], v[48:51], v[64:67]
    v_mfma_f32_16x16x32_bf16 v[68:71], v[148:151], v[48:51], v[68:71]
    v_mfma_f32_16x16x32_bf16 v[72:75], v[152:155], v[48:51], v[72:75]
    v_mfma_f32_16x16x32_bf16 v[76:79], v[156:159], v[48:51], v[76:79]
    s_waitcnt lgkmcnt(5)
    v_mfma_f32_16x16x32_bf16 v[60:63], v[80:83], v[52:55], v[60:63]
    v_mfma_f32_16x16x32_bf16 v[64:67], v[84:87], v[52:55], v[64:67]
    v_mfma_f32_16x16x32_bf16 v[68:71], v[88:91], v[52:55], v[68:71]
    v_mfma_f32_16x16x32_bf16 v[72:75], v[92:95], v[52:55], v[72:75]
    v_mfma_f32_16x16x32_bf16 v[76:79], v[96:99], v[52:55], v[76:79]
    s_waitcnt lgkmcnt(0)
    v_mfma_f32_16x16x32_bf16 v[60:63], v[100:103], v[56:59], v[60:63]
    v_mfma_f32_16x16x32_bf16 v[64:67], v[104:107], v[56:59], v[64:67]
    v_mfma_f32_16x16x32_bf16 v[68:71], v[108:111], v[56:59], v[68:71]
    v_mfma_f32_16x16x32_bf16 v[72:75], v[112:115], v[56:59], v[72:75]
    v_mfma_f32_16x16x32_bf16 v[76:79], v[116:119], v[56:59], v[76:79]
    s_branch P3_LO
P3_HI:
    ds_read_b128 v[120:123], v3 offset:24832
    ds_read_b128 v[124:127], v3 offset:25856
    ds_read_b128 v[128:131], v3 offset:26880
    ds_read_b128 v[132:135], v3 offset:27904
    ds_read_b128 v[136:139], v3 offset:28928
    ds_read_b128 v[140:143], v3 offset:29952
    ds_read_b128 v[144:147], v3 offset:30976
    ds_read_b128 v[148:151], v3 offset:32000
    ds_read_b128 v[152:155], v3 offset:33024
    ds_read_b128 v[156:159], v3 offset:34048
    ds_read_b128 v[80:83], v6 offset:58112
    ds_read_b128 v[84:87], v6 offset:59136
    ds_read_b128 v[88:91], v6 offset:60160
    ds_read_b128 v[92:95], v6 offset:61184
    ds_read_b128 v[96:99], v6 offset:62208
    s_waitcnt lgkmcnt(10)
    v_mfma_f32_16x16x32_bf16 v[60:63], v[120:123], v[20:23], v[60:63]
    ds_read_b128 v[100:103], v6 offset:63232
    v_mfma_f32_16x16x32_bf16 v[64:67], v[124:127], v[20:23], v[64:67]
    ds_read_b128 v[104:107], v6 offset:64256
    v_mfma_f32_16x16x32_bf16 v[68:71], v[128:131], v[20:23], v[68:71]
    ds_read_b128 v[108:111], v6 offset:65280
    v_mfma_f32_16x16x32_bf16 v[72:75], v[132:135], v[20:23], v[72:75]
    ds_read_b128 v[112:115], v7 offset:768
    v_mfma_f32_16x16x32_bf16 v[76:79], v[136:139], v[20:23], v[76:79]
    ds_read_b128 v[116:119], v7 offset:1792
    s_waitcnt lgkmcnt(10)
    v_mfma_f32_16x16x32_bf16 v[60:63], v[140:143], v[24:27], v[60:63]
    ds_read_b128 v[120:123], v7 offset:2816
    v_mfma_f32_16x16x32_bf16 v[64:67], v[144:147], v[24:27], v[64:67]
    ds_read_b128 v[124:127], v7 offset:3840
    v_mfma_f32_16x16x32_bf16 v[68:71], v[148:151], v[24:27], v[68:71]
    ds_read_b128 v[128:131], v7 offset:4864
    v_mfma_f32_16x16x32_bf16 v[72:75], v[152:155], v[24:27], v[72:75]
    ds_read_b128 v[132:135], v7 offset:5888
    v_mfma_f32_16x16x32_bf16 v[76:79], v[156:159], v[24:27], v[76:79]
    ds_read_b128 v[136:139], v7 offset:6912
    s_waitcnt lgkmcnt(10)
    v_mfma_f32_16x16x32_bf16 v[60:63], v[80:83], v[28:31], v[60:63]
    ds_read_b128 v[140:143], v7 offset:7936
    v_mfma_f32_16x16x32_bf16 v[64:67], v[84:87], v[28:31], v[64:67]
    ds_read_b128 v[144:147], v7 offset:8960
    v_mfma_f32_16x16x32_bf16 v[68:71], v[88:91], v[28:31], v[68:71]
    ds_read_b128 v[148:151], v7 offset:9984
    v_mfma_f32_16x16x32_bf16 v[72:75], v[92:95], v[28:31], v[72:75]
    ds_read_b128 v[152:155], v7 offset:11008
    v_mfma_f32_16x16x32_bf16 v[76:79], v[96:99], v[28:31], v[76:79]
    ds_read_b128 v[156:159], v3 offset:35072
    s_waitcnt lgkmcnt(10)
    v_mfma_f32_16x16x32_bf16 v[60:63], v[100:103], v[32:35], v[60:63]
    ds_read_b128 v[80:83], v3 offset:36096
    v_mfma_f32_16x16x32_bf16 v[64:67], v[104:107], v[32:35], v[64:67]
    ds_read_b128 v[84:87], v3 offset:37120
    v_mfma_f32_16x16x32_bf16 v[68:71], v[108:111], v[32:35], v[68:71]
    ds_read_b128 v[88:91], v3 offset:38144
    v_mfma_f32_16x16x32_bf16 v[72:75], v[112:115], v[32:35], v[72:75]
    ds_read_b128 v[92:95], v3 offset:39168
    v_mfma_f32_16x16x32_bf16 v[76:79], v[116:119], v[32:35], v[76:79]
    ds_read_b128 v[96:99], v3 offset:40192
    s_waitcnt lgkmcnt(10)
    v_mfma_f32_16x16x32_bf16 v[60:63], v[120:123], v[36:39], v[60:63]
    ds_read_b128 v[100:103], v3 offset:41216
    v_mfma_f32_16x16x32_bf16 v[64:67], v[124:127], v[36:39], v[64:67]
    ds_read_b128 v[104:107], v3 offset:42240
    v_mfma_f32_16x16x32_bf16 v[68:71], v[128:131], v[36:39], v[68:71]
    ds_read_b128 v[108:111], v3 offset:43264
    v_mfma_f32_16x16x32_bf16 v[72:75], v[132:135], v[36:39], v[72:75]
    ds_read_b128 v[112:115], v3 offset:44288
    v_mfma_f32_16x16x32_bf16 v[76:79], v[136:139], v[36:39], v[76:79]
    ds_read_b128 v[116:119], v3 offset:45312
    s_waitcnt lgkmcnt(10)
    v_mfma_f32_16x16x32_bf16 v[60:63], v[140:143], v[40:43], v[60:63]
    ds_read_b128 v[120:123], v3 offset:46336
    v_mfma_f32_16x16x32_bf16 v[64:67], v[144:147], v[40:43], v[64:67]
    ds_read_b128 v[124:127], v3 offset:47360
    v_mfma_f32_16x16x32_bf16 v[68:71], v[148:151], v[40:43], v[68:71]
    ds_read_b128 v[128:131], v3 offset:48384
    v_mfma_f32_16x16x32_bf16 v[72:75], v[152:155], v[40:43], v[72:75]
    ds_read_b128 v[132:135], v3 offset:49408
    v_mfma_f32_16x16x32_bf16 v[76:79], v[156:159], v[40:43], v[76:79]
    ds_read_b128 v[136:139], v3 offset:50432
    s_waitcnt lgkmcnt(10)
    v_mfma_f32_16x16x32_bf16 v[60:63], v[80:83], v[44:47], v[60:63]
    ds_read_b128 v[140:143], v3 offset:51456
    v_mfma_f32_16x16x32_bf16 v[64:67], v[84:87], v[44:47], v[64:67]
    ds_read_b128 v[144:147], v3 offset:52480
    v_mfma_f32_16x16x32_bf16 v[68:71], v[88:91], v[44:47], v[68:71]
    ds_read_b128 v[148:151], v3 offset:53504
    v_mfma_f32_16x16x32_bf16 v[72:75], v[92:95], v[44:47], v[72:75]
    ds_read_b128 v[152:155], v3 offset:54528
    v_mfma_f32_16x16x32_bf16 v[76:79], v[96:99], v[44:47], v[76:79]
    ds_read_b128 v[156:159], v3 offset:55552
    s_waitcnt lgkmcnt(10)
    v_mfma_f32_16x16x32_bf16 v[60:63], v[100:103], v[48:51], v[60:63]
    v_mfma_f32_16x16x32_bf16 v[64:67], v[104:107], v[48:51], v[64:67]
    v_mfma_f32_16x16x32_bf16 v[68:71], v[108:111], v[48:51], v[68:71]
    v_mfma_f32_16x16x32_bf16 v[72:75], v[112:115], v[48:51], v[72:75]
    v_mfma_f32_16x16x32_bf16 v[76:79], v[116:119], v[48:51], v[76:79]
    s_waitcnt lgkmcnt(5)
    v_mfma_f32_16x16x32_bf16 v[60:63], v[120:123], v[52:55], v[60:63]
    v_mfma_f32_16x16x32_bf16 v[64:67], v[124:127], v[52:55], v[64:67]
    v_mfma_f32_16x16x32_bf16 v[68:71], v[128:131], v[52:55], v[68:71]
    v_mfma_f32_16x16x32_bf16 v[72:75], v[132:135], v[52:55], v[72:75]
    v_mfma_f32_16x16x32_bf16 v[76:79], v[136:139], v[52:55], v[76:79]
    s_waitcnt lgkmcnt(0)
    v_mfma_f32_16x16x32_bf16 v[60:63], v[140:143], v[56:59], v[60:63]
    v_mfma_f32_16x16x32_bf16 v[64:67], v[144:147], v[56:59], v[64:67]
    v_mfma_f32_16x16x32_bf16 v[68:71], v[148:151], v[56:59], v[68:71]
    v_mfma_f32_16x16x32_bf16 v[72:75], v[152:155], v[56:59], v[72:75]
    v_mfma_f32_16x16x32_bf16 v[76:79], v[156:159], v[56:59], v[76:79]
P3_FD:
    ds_read_b32 v16, v19 offset:96
    s_waitcnt lgkmcnt(0)
    v_cmp_gt_u32 vcc, 1, v16
    s_nop 3
    s_and_b32 s14, vcc_lo, 15
    s_cbranch_scc0 P3_FD_OK
    s_sleep 1
    s_branch P3_FD
P3_FD_OK:
    s_lshl_b32 s14, s7, 2
    s_add_u32 s14, s14, 10352
    v_mov_b32 v14, s14
    ds_write_b128 v18, v[60:63] offset:0
    ds_write_b128 v18, v[64:67] offset:1024
    ds_write_b128 v18, v[68:71] offset:2048
    ds_write_b128 v18, v[72:75] offset:3072
    ds_write_b128 v18, v[76:79] offset:4096
    ds_write_b32 v14, v15
    s_waitcnt lgkmcnt(0)
    s_endpgm
P3_LO:
    s_lshl_b32 s12, 1, s7
P3_FP:
    ds_read_b32 v16, v19 offset:112
    s_waitcnt lgkmcnt(0)
    v_cmp_gt_u32 vcc, 1, v16
    s_nop 3
    s_and_b32 s14, vcc_lo, s12
    s_cbranch_scc1 P3_FP
P3_FP_OK:
    ds_read_b128 v[80:83], v18 offset:0
    ds_read_b128 v[84:87], v18 offset:1024
    ds_read_b128 v[88:91], v18 offset:2048
    ds_read_b128 v[92:95], v18 offset:3072
    ds_read_b128 v[96:99], v18 offset:4096
    s_waitcnt lgkmcnt(4)
    v_pk_add_f32 v[60:61], v[60:61], v[80:81]
    v_pk_add_f32 v[62:63], v[62:63], v[82:83]
    v_cvt_pk_bf16_f32 v20, v60, v61
    v_cvt_pk_bf16_f32 v21, v62, v63
    ds_write_b64 v8, v[20:21] offset:0
    s_waitcnt lgkmcnt(4)
    v_pk_add_f32 v[64:65], v[64:65], v[84:85]
    v_pk_add_f32 v[66:67], v[66:67], v[86:87]
    v_cvt_pk_bf16_f32 v22, v64, v65
    v_cvt_pk_bf16_f32 v23, v66, v67
    ds_write_b64 v8, v[22:23] offset:8
    s_waitcnt lgkmcnt(4)
    v_pk_add_f32 v[68:69], v[68:69], v[88:89]
    v_pk_add_f32 v[70:71], v[70:71], v[90:91]
    v_cvt_pk_bf16_f32 v24, v68, v69
    v_cvt_pk_bf16_f32 v25, v70, v71
    ds_write_b64 v8, v[24:25] offset:16
    s_waitcnt lgkmcnt(4)
    v_pk_add_f32 v[72:73], v[72:73], v[92:93]
    v_pk_add_f32 v[74:75], v[74:75], v[94:95]
    v_cvt_pk_bf16_f32 v26, v72, v73
    v_cvt_pk_bf16_f32 v27, v74, v75
    ds_write_b64 v8, v[26:27] offset:24
    s_waitcnt lgkmcnt(4)
    v_pk_add_f32 v[76:77], v[76:77], v[96:97]
    v_pk_add_f32 v[78:79], v[78:79], v[98:99]
    v_cvt_pk_bf16_f32 v28, v76, v77
    v_cvt_pk_bf16_f32 v29, v78, v79
    ds_write_b64 v8, v[28:29] offset:32
    ds_read_b128 v[32:35], v9 offset:0
    ds_read_b128 v[36:39], v9 offset:1024
    ds_read_b128 v[40:43], v9 offset:2048
    s_waitcnt lgkmcnt(2)
    buffer_store_dwordx4 v[32:35], v10, s[48:51], 0 offen nt
    s_waitcnt lgkmcnt(1)
    buffer_store_dwordx4 v[36:39], v11, s[48:51], 0 offen nt
    s_waitcnt lgkmcnt(0)
    s_mov_b32 exec_hi, 0
    buffer_store_dwordx4 v[40:43], v12, s[48:51], 0 offen nt
    s_endpgm
P3_EPI:
    v_mov_b32 v2, v0
    v_lshlrev_b32 v3, 4, v2
    s_lshl_b32 s33, s6, 6
    s_lshr_b32 s14, s4, 1
    s_lshl_b32 s14, s14, 5
    s_add_u32 s33, s33, s14
    s_and_b32 s14, s4, 1
    s_lshl_b32 s14, s14, 3
    s_add_u32 s33, s33, s14
    s_mul_i32 s34, s5, 160
    s_mul_i32 s35, s4, 5632
    s_add_u32 s35, s35, 105728
    s_cmp_eq_u32 s4, 3
    s_cselect_b32 s35, 143360, s35
    s_mul_i32 s14, s6, 10240
    s_add_u32 s20, s20, s14
    s_lshl_b32 s14, s4, 5
    s_add_u32 s20, s20, s14
    v_lshrrev_b32 v19, 1, v2
    v_lshlrev_b32 v19, 7, v19
    v_and_b32 v13, 1, v2
    v_lshl_add_u32 v19, v13, 4, v19
    s_lshr_b32 s14, s6, 4
    s_lshl_b32 s13, s5, 1
    s_add_u32 s13, s13, s14
    s_lshl_b32 s13, s13, 7
    s_add_u32 s13, s13, 11505664
    s_and_b32 s15, s6, 3
    s_lshl_b32 s15, s15, 11
    s_add_u32 s13, s13, s15
    v_mov_b32 v66, v5
    s_cmp_eq_u32 s14, 1
    s_cselect_b32 s12, 80, 48
    v_add_u32 v14, 0, v2
    v_mul_u32_u24 v10, 6554, v14
    v_lshrrev_b32 v10, 16, v10
    v_mul_u32_u24 v13, 10, v10
    v_sub_u32 v13, v14, v13
    v_lshl_add_u32 v13, v13, 4, s34
    v_and_b32 v14, 24, v10
    v_add3_u32 v10, v10, v14, s33
    v_mul_u32_u24 v10, 1280, v10
    v_add_u32 v16, v10, v13
    v_add_u32 v10, v10, v16
    v_add_u32 v14, 64, v2
    v_mul_u32_u24 v11, 6554, v14
    v_lshrrev_b32 v11, 16, v11
    v_mul_u32_u24 v13, 10, v11
    v_sub_u32 v13, v14, v13
    v_lshl_add_u32 v13, v13, 4, s34
    v_and_b32 v14, 24, v11
    v_add3_u32 v11, v11, v14, s33
    v_mul_u32_u24 v11, 1280, v11
    v_add_u32 v17, v11, v13
    v_add_u32 v11, v11, v17
    v_add_u32 v14, 128, v2
    v_mul_u32_u24 v12, 6554, v14
    v_lshrrev_b32 v12, 16, v12
    v_mul_u32_u24 v13, 10, v12
    v_sub_u32 v13, v14, v13
    v_lshl_add_u32 v13, v13, 4, s34
    v_and_b32 v14, 24, v12
    v_add3_u32 v12, v12, v14, s33
    v_mul_u32_u24 v12, 1280, v12
    v_add_u32 v18, v12, v13
    v_add_u32 v12, v12, v18
    s_mov_b32 s48, s38
    s_and_b32 s49, s39, 0xffff
    s_mov_b32 s50, 5242880
    s_mov_b32 s51, 0x20000
    s_cmp_eq_u32 s4, 3
    s_cbranch_scc0 P3_EN3
P3_EFG:
    ds_read_b32 v64, v5 offset:128
    s_waitcnt lgkmcnt(0)
    v_cmp_gt_u32 vcc, 1, v64
    s_nop 3
    s_and_b32 s14, vcc_lo, 1
    s_cbranch_scc0 P3_EFG_OK
    s_sleep 3
    s_branch P3_EFG
P3_EFG_OK:
    s_mov_b32 m0, 123648
    s_add_u32 s14, s86, 61440
    buffer_load_dwordx4 v3, s[44:47], s14 offen sc1 lds
    s_mov_b32 m0, 124672
    s_add_u32 s14, s86, 62464
    buffer_load_dwordx4 v3, s[44:47], s14 offen sc1 lds
    s_mov_b32 m0, 125696
    s_add_u32 s14, s86, 63488
    buffer_load_dwordx4 v3, s[44:47], s14 offen sc1 lds
    s_mov_b32 m0, 126720
    s_add_u32 s14, s86, 64512
    buffer_load_dwordx4 v3, s[44:47], s14 offen sc1 lds
    s_mov_b32 m0, 127744
    s_add_u32 s14, s86, 65536
    buffer_load_dwordx4 v3, s[44:47], s14 offen sc1 lds
    s_mov_b32 m0, 128768
    s_add_u32 s14, s86, 66560
    buffer_load_dwordx4 v3, s[44:47], s14 offen sc1 lds
    s_mov_b32 m0, 129792
    s_add_u32 s14, s86, 67584
    buffer_load_dwordx4 v3, s[44:47], s14 offen sc1 lds
    s_mov_b32 m0, 130816
    s_add_u32 s14, s86, 68608
    buffer_load_dwordx4 v3, s[44:47], s14 offen sc1 lds
    s_mov_b32 m0, 131840
    s_add_u32 s14, s86, 69632
    buffer_load_dwordx4 v3, s[44:47], s14 offen sc1 lds
    s_mov_b32 m0, 132864
    s_add_u32 s14, s86, 70656
    buffer_load_dwordx4 v3, s[44:47], s14 offen sc1 lds
    s_mov_b32 m0, 133888
    s_add_u32 s14, s86, 71680
    buffer_load_dwordx4 v3, s[44:47], s14 offen sc1 lds
    s_mov_b32 m0, 134912
    s_add_u32 s14, s86, 72704
    buffer_load_dwordx4 v3, s[44:47], s14 offen sc1 lds
    s_mov_b32 m0, 135936
    s_add_u32 s14, s86, 73728
    buffer_load_dwordx4 v3, s[44:47], s14 offen sc1 lds
    s_mov_b32 m0, 136960
    s_add_u32 s14, s86, 74752
    buffer_load_dwordx4 v3, s[44:47], s14 offen sc1 lds
    s_mov_b32 m0, 137984
    s_add_u32 s14, s86, 75776
    buffer_load_dwordx4 v3, s[44:47], s14 offen sc1 lds
    s_mov_b32 m0, 139008
    s_add_u32 s14, s86, 76800
    buffer_load_dwordx4 v3, s[44:47], s14 offen sc1 lds
    s_mov_b32 m0, 140032
    s_add_u32 s14, s86, 77824
    buffer_load_dwordx4 v3, s[44:47], s14 offen sc1 lds
    s_mov_b32 m0, 141056
    s_add_u32 s14, s86, 78848
    buffer_load_dwordx4 v3, s[44:47], s14 offen sc1 lds
    s_mov_b32 m0, 142080
    s_add_u32 s14, s86, 79872
    buffer_load_dwordx4 v3, s[44:47], s14 offen sc1 lds
    v_mov_b32 v64, 10312
    v_mov_b32 v65, 1
    s_waitcnt vmcnt(0)
    ds_write_b32 v64, v65
P3_EN3:
P3_EFD:
    ds_read_b32 v64, v5 offset:96
    s_waitcnt lgkmcnt(0)
    v_cmp_gt_u32 vcc, 1, v64
    s_nop 3
    s_and_b32 s14, vcc_lo, 15
    s_cbranch_scc0 P3_EFD_OK
    s_sleep 3
    s_branch P3_EFD
P3_EFD_OK:
    s_add_u32 m0, s35, 0
    s_nop 0
    buffer_load_dwordx4 v16, s[56:59], 0 offen lds
    s_add_u32 m0, s35, 1024
    s_nop 0
    buffer_load_dwordx4 v17, s[56:59], 0 offen lds
    s_add_u32 m0, s35, 2048
    s_nop 0
    buffer_load_dwordx4 v18, s[56:59], 0 offen lds
    v_bfe_u32 v4, v2, 3, 1
    v_and_b32 v5, 3, v2
    v_lshl_add_u32 v4, v5, 1, v4
    v_bfe_u32 v5, v2, 2, 1
    v_lshl_add_u32 v4, v5, 3, v4
    v_mul_u32_u24 v6, 160, v4
    v_lshrrev_b32 v5, 4, v2
    v_lshl_add_u32 v6, v5, 3, v6
    v_add_u32 v6, s35, v6
    v_lshl_add_u32 v7, v2, 3, s35
    v_add_u32 v8, s35, v3
P3_YD:
    ds_read_b32 v64, v66 offset:64
    s_waitcnt lgkmcnt(0)
    v_cmp_gt_u32 vcc, 1, v64
    s_nop 3
    s_and_b32 s14, vcc_lo, 63
    s_cbranch_scc0 P3_YD_OK
    s_sleep 4
    s_branch P3_YD
P3_YD_OK:
    s_add_u32 s21, s20, 4096
    s_add_u32 s22, s20, 8192
    v_mov_b32 v76, 0
    v_mov_b32 v77, 0
    v_mov_b32 v78, 0
    v_mov_b32 v79, 0
P3_YP:
    buffer_load_dwordx4 v[68:71], v19, s[44:47], s20 offen sc1
    buffer_load_dwordx4 v[72:75], v19, s[44:47], s21 offen sc1
    s_mov_b32 exec_hi, 0
    buffer_load_dwordx4 v[76:79], v19, s[44:47], s22 offen sc1
    s_mov_b64 exec, -1
    s_waitcnt vmcnt(0)
    v_max3_u32 v64, v68, v69, v70
    v_max3_u32 v64, v64, v71, v72
    v_max3_u32 v64, v64, v73, v74
    v_max3_u32 v64, v64, v75, v76
    v_max3_u32 v64, v64, v77, v78
    v_max_u32 v64, v64, v79
    v_cmp_eq_u32 vcc, -1, v64
    s_nop 3
    s_cbranch_vccz P3_YG
    s_sleep 6
    s_branch P3_YP
P3_YG:
    ds_write_b128 v8, v[68:71] offset:3072
    ds_write_b128 v8, v[72:75] offset:4096
    s_mov_b32 exec_hi, 0
    ds_write_b128 v8, v[76:79] offset:5120
    s_mov_b64 exec, -1
    ds_read_b64_tr_b16 v[20:21], v7 offset:3072
    ds_read_b64 v[32:33], v6 offset:0
    ds_read_b64_tr_b16 v[22:23], v7 offset:3584
    ds_read_b64 v[34:35], v6 offset:32
    ds_read_b64_tr_b16 v[24:25], v7 offset:4096
    ds_read_b64 v[36:37], v6 offset:64
    ds_read_b64_tr_b16 v[26:27], v7 offset:4608
    ds_read_b64 v[38:39], v6 offset:96
    ds_read_b64_tr_b16 v[28:29], v7 offset:5120
    ds_read_b64 v[40:41], v6 offset:128
    s_waitcnt lgkmcnt(8)
    v_lshlrev_b32 v44, 16, v20
    v_and_b32 v45, 0xffff0000, v20
    v_lshlrev_b32 v46, 16, v32
    v_and_b32 v47, 0xffff0000, v32
    v_pk_mul_f32 v[44:45], v[44:45], v[46:47]
    v_cvt_pk_bf16_f32 v32, v44, v45
    v_lshlrev_b32 v48, 16, v21
    v_and_b32 v49, 0xffff0000, v21
    v_lshlrev_b32 v50, 16, v33
    v_and_b32 v51, 0xffff0000, v33
    v_pk_mul_f32 v[48:49], v[48:49], v[50:51]
    v_cvt_pk_bf16_f32 v33, v48, v49
    ds_write_b64 v6, v[32:33] offset:0
    s_waitcnt lgkmcnt(7)
    v_lshlrev_b32 v44, 16, v22
    v_and_b32 v45, 0xffff0000, v22
    v_lshlrev_b32 v46, 16, v34
    v_and_b32 v47, 0xffff0000, v34
    v_pk_mul_f32 v[44:45], v[44:45], v[46:47]
    v_cvt_pk_bf16_f32 v34, v44, v45
    v_lshlrev_b32 v48, 16, v23
    v_and_b32 v49, 0xffff0000, v23
    v_lshlrev_b32 v50, 16, v35
    v_and_b32 v51, 0xffff0000, v35
    v_pk_mul_f32 v[48:49], v[48:49], v[50:51]
    v_cvt_pk_bf16_f32 v35, v48, v49
    ds_write_b64 v6, v[34:35] offset:32
    s_waitcnt lgkmcnt(6)
    v_lshlrev_b32 v44, 16, v24
    v_and_b32 v45, 0xffff0000, v24
    v_lshlrev_b32 v46, 16, v36
    v_and_b32 v47, 0xffff0000, v36
    v_pk_mul_f32 v[44:45], v[44:45], v[46:47]
    v_cvt_pk_bf16_f32 v36, v44, v45
    v_lshlrev_b32 v48, 16, v25
    v_and_b32 v49, 0xffff0000, v25
    v_lshlrev_b32 v50, 16, v37
    v_and_b32 v51, 0xffff0000, v37
    v_pk_mul_f32 v[48:49], v[48:49], v[50:51]
    v_cvt_pk_bf16_f32 v37, v48, v49
    ds_write_b64 v6, v[36:37] offset:64
    s_waitcnt lgkmcnt(5)
    v_lshlrev_b32 v44, 16, v26
    v_and_b32 v45, 0xffff0000, v26
    v_lshlrev_b32 v46, 16, v38
    v_and_b32 v47, 0xffff0000, v38
    v_pk_mul_f32 v[44:45], v[44:45], v[46:47]
    v_cvt_pk_bf16_f32 v38, v44, v45
    v_lshlrev_b32 v48, 16, v27
    v_and_b32 v49, 0xffff0000, v27
    v_lshlrev_b32 v50, 16, v39
    v_and_b32 v51, 0xffff0000, v39
    v_pk_mul_f32 v[48:49], v[48:49], v[50:51]
    v_cvt_pk_bf16_f32 v39, v48, v49
    ds_write_b64 v6, v[38:39] offset:96
    s_waitcnt lgkmcnt(4)
    v_lshlrev_b32 v44, 16, v28
    v_and_b32 v45, 0xffff0000, v28
    v_lshlrev_b32 v46, 16, v40
    v_and_b32 v47, 0xffff0000, v40
    v_pk_mul_f32 v[44:45], v[44:45], v[46:47]
    v_cvt_pk_bf16_f32 v40, v44, v45
    v_lshlrev_b32 v48, 16, v29
    v_and_b32 v49, 0xffff0000, v29
    v_lshlrev_b32 v50, 16, v41
    v_and_b32 v51, 0xffff0000, v41
    v_pk_mul_f32 v[48:49], v[48:49], v[50:51]
    v_cvt_pk_bf16_f32 v41, v48, v49
    ds_write_b64 v6, v[40:41] offset:128
    ds_read_b128 v[52:55], v8 offset:0
    ds_read_b128 v[56:59], v8 offset:1024
    ds_read_b128 v[60:63], v8 offset:2048
    s_waitcnt lgkmcnt(2)
    buffer_store_dwordx4 v[52:55], v10, s[48:51], 0 offen nt
    s_waitcnt lgkmcnt(1)
    buffer_store_dwordx4 v[56:59], v11, s[48:51], 0 offen nt
    s_waitcnt lgkmcnt(0)
    s_mov_b32 exec_hi, 0
    buffer_store_dwordx4 v[60:63], v12, s[48:51], 0 offen nt
KM_END:
    s_endpgm
.section .rodata,"a"
.p2align 6
.amdhsa_kernel main_kernel
  .amdhsa_next_free_vgpr 168
  .amdhsa_next_free_sgpr 100
  .amdhsa_accum_offset 168
  .amdhsa_group_segment_fixed_size 0
  .amdhsa_kernarg_size 112
  .amdhsa_user_sgpr_count 2
  .amdhsa_user_sgpr_kernarg_segment_ptr 1
  .amdhsa_system_sgpr_workgroup_id_x 1
.end_amdhsa_kernel
```
